```python
import torch

def _softmax(x, axis=-1):
    return torch.softmax(x, dim=axis)

def _gelu(x):
    return torch.nn.functional.gelu(x, approximate='tanh')

def _silu(x):
    return torch.nn.functional.silu(x)

def _sigmoid(x):
    return torch.sigmoid(x)

def _layernorm(x, axis=-1, eps=1e-05):
    m = x.mean(dim=axis, keepdim=True)
    v = x.var(dim=axis, keepdim=True, unbiased=False)
    return (x - m) / torch.sqrt(v + eps)

def _scatter_add(tgt, idx, src, axis=0):
    return tgt.clone().index_add_(axis, idx, src)

def _segment_sum(src, seg, n):
    out = torch.zeros((n,) + src.shape[1:], dtype=src.dtype)
    return out.index_add_(0, seg, src)

def _pad(x, pw):
    flat = tuple((v for pair in reversed(pw) for v in pair))
    return torch.nn.functional.pad(x, flat)
kernel_name = 'adaLN_cond__spectral_fnet__geglu_ffn__prompt'

def setup_inputs():

    _w = lambda a: (lambda t: t.to(torch.bfloat16) if t.is_floating_point() else t)(torch.as_tensor(a))

    def _A_setup():
        B, S, D = (1, 2048, 448)
        ns = torch.arange(S)[:, None] * torch.arange(S)[None, :]
        nd = torch.arange(D)[:, None] * torch.arange(D)[None, :]
        Ws_re = torch.cos(-2.0 * torch.pi * ns / S).to(float)
        Ws_im = torch.sin(-2.0 * torch.pi * ns / S).to(float)
        Wd_re = torch.cos(-2.0 * torch.pi * nd / D).to(float)
        Wd_im = torch.sin(-2.0 * torch.pi * nd / D).to(float)
        return {'x': _w((lambda *s: torch.randn(*s, dtype=torch.bfloat16) * 0.05)(B, S, D)), 'dft_seq_re': _w(Ws_re), 'dft_seq_im': _w(Ws_im), 'dft_hid_re': _w(Wd_re), 'dft_hid_im': _w(Wd_im)}
    _A_in = _A_setup()

    def _B_setup():
        B, S, D, F = (1, 2048, 448, 1792)
        return {'x': _w((lambda *s: torch.randn(*s, dtype=torch.bfloat16) * 0.05)(B, S, D)), 'w_gate': _w((lambda *s: torch.randn(*s, dtype=torch.bfloat16) * 0.4)(D, F)), 'w_up': _w((lambda *s: torch.randn(*s, dtype=torch.bfloat16) * 0.4)(D, F)), 'w_down': _w((lambda *s: torch.randn(*s, dtype=torch.bfloat16) * 0.4)(F, D))}
    _B_in = _B_setup()
    return {'A_x': _A_in['x'], 'A_dft_seq_re': _A_in['dft_seq_re'], 'A_dft_seq_im': _A_in['dft_seq_im'], 'A_dft_hid_re': _A_in['dft_hid_re'], 'A_dft_hid_im': _A_in['dft_hid_im'], 'B_x': _B_in['x'], 'B_w_gate': _B_in['w_gate'], 'B_w_up': _B_in['w_up'], 'B_w_down': _B_in['w_down'], 'c': _w((lambda *s: torch.randn(*s, dtype=torch.bfloat16) * 0.2)(1, 448) * 8.0), 'w_mod': _w((lambda *s: torch.randn(*s, dtype=torch.bfloat16) * 0.2)(448, 6 * 448) * 448 ** (-0.5) * 8.0)}

def reference(A_x, A_dft_seq_re, A_dft_seq_im, A_dft_hid_re, A_dft_hid_im, B_x, B_w_gate, B_w_up, B_w_down, c, w_mod):

    def _A_ref(x, dft_seq_re, dft_seq_im, dft_hid_re, dft_hid_im):
        a = torch.einsum('bsd,ed->bse', x, dft_hid_re)
        b = torch.einsum('bsd,ed->bse', x, dft_hid_im)
        y = torch.einsum('ts,bse->bte', dft_seq_re, a) - torch.einsum('ts,bse->bte', dft_seq_im, b)
        return y

    def _B_ref(x, w_gate, w_up, w_down):
        return _gelu(x @ w_gate) * (x @ w_up) @ w_down
    x = A_x
    mod = (_silu(c) @ w_mod).reshape(c.shape[0], 6, 1, -1)
    sa, ca, ga, sb, cb, gb = (mod[:, 0].clone(), mod[:, 1].clone(), mod[:, 2].clone(), mod[:, 3].clone(), mod[:, 4].clone(), mod[:, 5].clone())
    h = _layernorm(x, axis=-1) * (1 + ca) + sa
    x = x + ga * _A_ref(h, A_dft_seq_re, A_dft_seq_im, A_dft_hid_re, A_dft_hid_im)
    h = _layernorm(x, axis=-1) * (1 + cb) + sb
    x = x + gb * _B_ref(h, B_w_gate, B_w_up, B_w_down)
    return x
```

```asm
; @launch grid=(256,1,1) block=(256,1,1) lds=163840
.amdgcn_target "amdgcn-amd-amdhsa--gfx950"
.text
.p2align 12
.globl adaLN_cond__spectral_fnet__geglu_ffn__prompt_kernel
.p2align 8
.type adaLN_cond__spectral_fnet__geglu_ffn__prompt_kernel,@function
adaLN_cond__spectral_fnet__geglu_ffn__prompt_kernel:
    s_load_dwordx2 s[4:5], s[0:1], 0
    s_load_dwordx2 s[6:7], s[0:1], 104
    s_load_dwordx8 s[8:15], s[0:1], 48
    s_load_dwordx4 s[60:63], s[0:1], 80
    s_cmp_ge_u32 s2, 256
    s_cbranch_scc1 L_end
    s_getpc_b64 s[64:65]
L_pc:
    s_lshr_b32 s17, s2, 3
    v_lshl_add_u32 v2, v0, 5, s17
    v_lshlrev_b32 v2, 7, v2
    v_cmp_gt_u32 vcc, L_codeend-L_pc, v2
    v_lshrrev_b32 v3, 6, v0
    s_and_saveexec_b64 s[66:67], vcc
    s_cbranch_execz L_nopf
    global_load_dword v64, v2, s[64:65]
L_nopf:
    s_mov_b64 exec, -1
    v_and_b32 v1, 63, v0
    v_readfirstlane_b32 s20, v3
    s_and_b32 s16, s2, 7
    v_lshrrev_b32 v5, 4, v1
    v_and_b32 v6, 15, v1
    v_lshlrev_b32 v4, 4, v1
    v_lshrrev_b32 v40, 3, v1
    v_and_b32 v41, 7, v1
    s_lshl_b32 s18, s20, 4
    v_add_u32 v7, s18, v6
    v_cvt_f32_u32 v42, v5
    v_mul_f32 v42, 4.0, v42
    s_cmp_ge_u32 s2, 128
    s_cbranch_scc1 L_notmain
    s_lshr_b32 s49, s17, 2
    s_and_b32 s50, s49, 1
    s_lshl1_add_u32 s48, s16, s50
    s_sub_u32 s50, 32, s48
    s_cmp_eq_u32 s50, 32
    s_cselect_b32 s50, 16, s50
    s_cmp_lt_u32 s49, 2
    s_cselect_b32 s48, s48, s50
    s_and_b32 s49, s17, 3
    v_mul_u32_u24 v65, 28672, v40
    v_lshl_add_u32 v65, v41, 4, v65
    s_mul_i32 s50, s48, 896
    s_mul_i32 s51, s20, 458752
    s_add_u32 s50, s50, s51
    s_and_b32 s52, s49, 1
    s_mul_i32 s53, s52, 229376
    s_add_u32 s51, s50, 229376
    s_sub_u32 s101, s51, s53
    s_add_u32 s100, s50, s53
    v_lshrrev_b32 v93, 1, v7
    v_and_b32 v94, 1, v7
    v_cmp_eq_u32 vcc, 1, v7
    v_mov_b32 v207, 0x3f803f80
    s_nop 0
    v_cndmask_b32 v93, v93, 32, vcc
    v_cndmask_b32 v94, v94, 0, vcc
    v_cvt_f32_u32 v93, v93
    v_cvt_f32_u32 v94, v94
    v_mul_f32 v93, 0x3c800000, v93
    v_mul_f32 v94, 0x3e800000, v94
    v_fma_f32 v94, v93, v42, v94
    v_fmamk_f32 v96, v93, 0x00000000, v94
    v_fmamk_f32 v97, v93, 0x3f800000, v94
    v_fmamk_f32 v98, v93, 0x40000000, v94
    v_fmamk_f32 v99, v93, 0x40400000, v94
    v_fmamk_f32 v100, v93, 0x41800000, v94
    v_fmamk_f32 v101, v93, 0x41880000, v94
    v_fmamk_f32 v102, v93, 0x41900000, v94
    v_fmamk_f32 v103, v93, 0x41980000, v94
    v_fmamk_f32 v104, v93, 0x42000000, v94
    v_fmamk_f32 v105, v93, 0x42040000, v94
    v_fmamk_f32 v106, v93, 0x42080000, v94
    v_fmamk_f32 v107, v93, 0x420c0000, v94
    v_fmamk_f32 v108, v93, 0x42400000, v94
    v_fmamk_f32 v109, v93, 0x42440000, v94
    v_fmamk_f32 v110, v93, 0x42480000, v94
    v_fmamk_f32 v111, v93, 0x424c0000, v94
    v_cos_f32 v96, v96
    v_cos_f32 v97, v97
    v_cos_f32 v98, v98
    v_cos_f32 v99, v99
    v_cos_f32 v100, v100
    v_cos_f32 v101, v101
    v_cos_f32 v102, v102
    v_cos_f32 v103, v103
    v_cos_f32 v104, v104
    v_cos_f32 v105, v105
    v_cos_f32 v106, v106
    v_cos_f32 v107, v107
    v_cos_f32 v108, v108
    v_cos_f32 v109, v109
    v_cos_f32 v110, v110
    v_cos_f32 v111, v111
    s_waitcnt lgkmcnt(0)
    s_mov_b32 s24, s4
    s_and_b32 s25, s5, 0xffff
    s_mov_b32 s26, 0x1c0000
    s_mov_b32 s27, 0x20000
    buffer_load_dwordx4 v[128:131], v65, s[24:27], s100 offen offset:0
    buffer_load_dwordx4 v[132:135], v65, s[24:27], s100 offen offset:128
    buffer_load_dwordx4 v[136:139], v65, s[24:27], s100 offen offset:256
    buffer_load_dwordx4 v[140:143], v65, s[24:27], s100 offen offset:384
    s_mov_b32 s28, s6
    s_and_b32 s29, s7, 0xffff
    s_mov_b32 s30, 0x1000000
    s_mov_b32 s31, 0x20000
    v_lshlrev_b32 v206, 17, v5
    v_lshl_add_u32 v206, v6, 4, v206
    s_lshl_b32 s44, s20, 19
    s_lshl_b32 s54, s48, 10
    s_add_u32 s44, s44, s54
    s_lshl_b32 s54, s49, 8
    s_add_u32 s44, s44, s54
    s_add_u32 s45, s44, 32768
    v_add_u32 v184, 65536, v206
    buffer_load_dwordx4 v[144:147], v65, s[24:27], s100 offen offset:512
    v_mov_b32 v248, 0
    v_mov_b32 v249, 0
    v_mov_b32 v250, 0
    v_mov_b32 v251, 0
    s_add_u32 s54, s6, 0x220000
    s_addc_u32 s55, s7, 0
    s_load_dword s56, s[54:55], 0
    v_lshrrev_b32 v92, 2, v1
    v_mul_u32_u24 v92, 224, v92
    v_and_b32 v93, 3, v1
    v_lshl_add_u32 v92, v93, 3, v92
    v_add_u32 v200, 114688, v92
    v_add_u32 v92, s18, v40
    buffer_load_dwordx4 v[148:151], v65, s[24:27], s100 offen offset:640
    v_mul_u32_u24 v92, 224, v92
    v_and_b32 v93, 1, v41
    v_lshl_add_u32 v92, v93, 4, v92
    v_lshrrev_b32 v93, 1, v41
    v_cmp_eq_u32 vcc, s49, v93
    v_mov_b32 v93, 0x14000
    s_mul_i32 s55, s52, 1792
    v_cndmask_b32 v92, v93, v92, vcc
    s_add_u32 s54, s55, 114688
    v_add_u32 v201, s54, v92
    s_sub_u32 s54, 116480, s55
    v_add_u32 v202, s54, v92
    v_lshrrev_b32 v92, 2, v41
    buffer_load_dwordx4 v[152:155], v65, s[24:27], s100 offen offset:768
    v_xor_b32 v92, s52, v92
    v_lshl_add_u32 v93, v92, 3, v40
    v_add_u32 v203, s18, v93
    v_lshlrev_b32 v203, 2, v203
    v_add_u32 v203, 131072, v203
    v_lshrrev_b32 v92, 2, v93
    v_and_b32 v93, 3, v93
    v_lshl_add_u32 v93, v92, 3, v93
    s_lshr_b32 s54, s20, 1
    s_lshl_b32 s54, s54, 5
    s_and_b32 s55, s20, 1
    s_lshl_b32 s55, s55, 2
    s_add_u32 s54, s54, s55
    buffer_load_dwordx4 v[156:159], v65, s[24:27], s101 offen offset:0
    s_add_u32 s54, s54, 65536
    v_add_lshl_u32 v204, v93, s54, 1
    v_lshlrev_b32 v205, 4, v5
    v_add_u32 v205, 131072, v205
    v_cmp_lt_u32 s[0:1], 3, v41
    s_mov_b32 s53, 0x11111111
    buffer_load_dwordx4 v[160:163], v65, s[24:27], s101 offen offset:128
    v_cvt_f32_u32 v90, v7
    v_mul_f32 v77, 0x3b124925, v90
    v_mul_f32 v78, 0x3b924925, v90
    v_mul_f32 v79, 0x3bdb6db7, v90
    v_cos_f32 v32, v77
    v_sin_f32 v33, v77
    v_cos_f32 v34, v78
    v_sin_f32 v35, v78
    v_cos_f32 v36, v79
    buffer_load_dwordx4 v[164:167], v65, s[24:27], s101 offen offset:256
    v_sin_f32 v37, v79
    v_mul_f32 v90, 0x3c800000, v90
    v_mul_f32 v91, v90, v42
    v_fmamk_f32 v76, v90, 0x00000000, v91
    v_fmamk_f32 v77, v90, 0x3f800000, v91
    v_fmamk_f32 v78, v90, 0x40000000, v91
    v_fmamk_f32 v79, v90, 0x40400000, v91
    v_cos_f32 v80, v76
    v_sin_f32 v84, v76
    v_cos_f32 v81, v77
    buffer_load_dwordx4 v[168:171], v65, s[24:27], s101 offen offset:384
    v_sin_f32 v85, v77
    v_cos_f32 v82, v78
    v_sin_f32 v86, v78
    v_cos_f32 v83, v79
    v_sin_f32 v87, v79
    v_cvt_pk_bf16_f32 v16, v80, v84
    v_cvt_pk_bf16_f32 v17, v81, v85
    v_cvt_pk_bf16_f32 v18, v82, v86
    buffer_load_dwordx4 v[172:175], v65, s[24:27], s101 offen offset:512
    v_cvt_pk_bf16_f32 v19, v83, v87
    v_fmamk_f32 v76, v90, 0x41800000, v91
    v_fmamk_f32 v77, v90, 0x41880000, v91
    v_fmamk_f32 v78, v90, 0x41900000, v91
    v_fmamk_f32 v79, v90, 0x41980000, v91
    v_cos_f32 v80, v76
    v_sin_f32 v84, v76
    v_cos_f32 v81, v77
    v_sin_f32 v85, v77
    v_cos_f32 v82, v78
    v_sin_f32 v86, v78
    v_cos_f32 v83, v79
    v_sin_f32 v87, v79
    v_cvt_pk_bf16_f32 v20, v80, v84
    v_cvt_pk_bf16_f32 v21, v81, v85
    v_cvt_pk_bf16_f32 v22, v82, v86
    v_cvt_pk_bf16_f32 v23, v83, v87
    v_fmamk_f32 v76, v90, 0x42000000, v91
    v_fmamk_f32 v77, v90, 0x42040000, v91
    v_fmamk_f32 v78, v90, 0x42080000, v91
    v_fmamk_f32 v79, v90, 0x420c0000, v91
    v_cos_f32 v80, v76
    v_sin_f32 v84, v76
    v_cos_f32 v81, v77
    v_sin_f32 v85, v77
    v_cos_f32 v82, v78
    v_sin_f32 v86, v78
    v_cos_f32 v83, v79
    v_sin_f32 v87, v79
    v_cvt_pk_bf16_f32 v24, v80, v84
    v_cvt_pk_bf16_f32 v25, v81, v85
    v_cvt_pk_bf16_f32 v26, v82, v86
    v_cvt_pk_bf16_f32 v27, v83, v87
    v_fmamk_f32 v76, v90, 0x42400000, v91
    v_fmamk_f32 v77, v90, 0x42440000, v91
    v_fmamk_f32 v78, v90, 0x42480000, v91
    v_fmamk_f32 v79, v90, 0x424c0000, v91
    v_cos_f32 v80, v76
    v_sin_f32 v84, v76
    v_cos_f32 v81, v77
    v_sin_f32 v85, v77
    v_cos_f32 v82, v78
    v_sin_f32 v86, v78
    v_cos_f32 v83, v79
    v_sin_f32 v87, v79
    v_cvt_pk_bf16_f32 v28, v80, v84
    v_cvt_pk_bf16_f32 v29, v81, v85
    v_cvt_pk_bf16_f32 v30, v82, v86
    v_cvt_pk_bf16_f32 v31, v83, v87
    v_and_b32 v80, 2, v40
    v_xor_b32 v81, v41, v80
    v_mul_u32_u24 v61, 896, v40
    v_lshl_add_u32 v61, v81, 4, v61
    v_bfe_u32 v81, v1, 2, 2
    v_lshl_add_u32 v82, v5, 3, v81
    v_lshlrev_b32 v82, 7, v82
    v_and_b32 v83, 3, v1
    v_lshl_add_u32 v82, v83, 3, v82
    v_lshrrev_b32 v83, 1, v81
    v_and_b32 v80, 1, v5
    v_lshl_add_u32 v83, v80, 1, v83
    v_lshl_add_u32 v62, v83, 5, v82
    s_lshl_b32 s55, s20, 5
    v_xor_b32 v39, s55, v62
    v_add_u32 v63, 57344, v39
    v_lshlrev_b32 v3, 2, v7
    v_mul_u32_u24 v49, 1088, v5
    v_add_u32 v49, v49, v3
    v_add_u32 v49, 114688, v49
    v_mul_u32_u24 v50, 272, v6
    v_lshl_add_u32 v50, v5, 4, v50
    v_add_u32 v50, 114688, v50
    v_lshlrev_b32 v51, 11, v41
    v_and_b32 v80, 1, v41
    v_lshl_add_u32 v51, v80, 7, v51
    v_bfe_u32 v80, v41, 1, 1
    v_lshl_add_u32 v51, v80, 6, v51
    v_lshrrev_b32 v80, 2, v41
    v_lshl_add_u32 v51, v80, 4, v51
    v_lshl_add_u32 v51, v40, 5, v51
    s_mul_i32 s55, s20, 448
    s_add_u32 s54, s55, 123392
    v_add_u32 v51, s54, v51
    s_add_u32 s54, s55, 3584
    v_add_u32 v47, s54, v4
    v_lshlrev_b32 v59, 5, v41
    v_add_u32 v59, 141824, v59
    v_lshl_add_u32 v58, v5, 4, v59
    s_lshl_b32 s54, s20, 2
    v_add_u32 v58, s54, v58
    s_mul_i32 s54, s20, 1536
    s_add_u32 s54, s54, 154624
    v_add_u32 v44, s54, v4
    v_cmp_gt_u32 vcc, 28, v1
    v_mov_b32 v80, 0x30000
    s_nop 0
    v_cndmask_b32 v44, v80, v44, vcc
    v_lshlrev_b32 v45, 5, v40
    v_add_u32 v45, s54, v45
    v_mul_u32_u24 v43, 896, v41
    v_lshl_add_u32 v43, v40, 4, v43
    s_mul_i32 s54, s20, 224
    s_add_u32 s54, s54, 147456
    v_add_u32 v43, s54, v43
    s_lshr_b32 s54, s17, 3
    s_and_b32 s55, s54, 1
    s_lshl1_add_u32 s40, s16, s55
    s_sub_u32 s55, 32, s40
    s_cmp_eq_u32 s55, 32
    s_cselect_b32 s55, 16, s55
    s_cmp_lt_u32 s54, 2
    s_cselect_b32 s40, s40, s55
    s_and_b32 s41, s17, 7
    s_lshl3_add_u32 s21, s40, s41
    s_lshl_b32 s36, s41, 8
    s_add_u32 s36, s36, s40
    s_sub_u32 s54, s36, 992
    s_mov_b64 exec, 0
    s_cmp_eq_u32 s20, 0
    s_cbranch_scc1 L_pad0
    s_cmp_eq_u32 s20, 1
    s_cbranch_scc1 L_pad1
    s_cmp_eq_u32 s20, 2
    s_cbranch_scc1 L_pad2
    s_branch L_pad3
L_padret:
    s_mov_b64 exec, -1
    s_cmp_ge_u32 s2, 128
    s_cbranch_scc1 L_padret2
    s_waitcnt lgkmcnt(0)
    s_add_u32 s56, s56, 0x10001
    s_and_b32 s56, s56, 0x9fff9fff
    s_or_b32 s56, s56, 0x20002000
    s_and_b32 s57, s56, 0xffff0000
    s_and_b32 s58, s56, 0xffff
    s_waitcnt vmcnt(11)
    buffer_load_dwordx4 v[176:179], v65, s[24:27], s101 offen offset:640
    ds_write_b128 v201, v[128:131] offset:0
    v_dot2c_f32_bf16 v248, v128, v128
    v_dot2c_f32_bf16 v249, v128, v207
    v_dot2c_f32_bf16 v248, v129, v129
    v_dot2c_f32_bf16 v249, v129, v207
    v_dot2c_f32_bf16 v248, v130, v130
    v_dot2c_f32_bf16 v249, v130, v207
    v_dot2c_f32_bf16 v248, v131, v131
    v_dot2c_f32_bf16 v249, v131, v207
    s_waitcnt vmcnt(11)
    buffer_load_dwordx4 v[180:183], v65, s[24:27], s101 offen offset:768
    ds_write_b128 v201, v[132:135] offset:32
    v_dot2c_f32_bf16 v248, v132, v132
    v_dot2c_f32_bf16 v249, v132, v207
    v_dot2c_f32_bf16 v248, v133, v133
    v_dot2c_f32_bf16 v249, v133, v207
    v_dot2c_f32_bf16 v248, v134, v134
    v_dot2c_f32_bf16 v249, v134, v207
    v_dot2c_f32_bf16 v248, v135, v135
    v_dot2c_f32_bf16 v249, v135, v207
    s_waitcnt vmcnt(11)
    ds_write_b128 v201, v[136:139] offset:64
    v_dot2c_f32_bf16 v248, v136, v136
    v_dot2c_f32_bf16 v249, v136, v207
    v_dot2c_f32_bf16 v248, v137, v137
    v_dot2c_f32_bf16 v249, v137, v207
    v_dot2c_f32_bf16 v248, v138, v138
    v_dot2c_f32_bf16 v249, v138, v207
    v_dot2c_f32_bf16 v248, v139, v139
    v_dot2c_f32_bf16 v249, v139, v207
    s_waitcnt vmcnt(10)
    ds_write_b128 v201, v[140:143] offset:96
    v_dot2c_f32_bf16 v248, v140, v140
    v_dot2c_f32_bf16 v249, v140, v207
    v_dot2c_f32_bf16 v248, v141, v141
    v_dot2c_f32_bf16 v249, v141, v207
    v_dot2c_f32_bf16 v248, v142, v142
    v_dot2c_f32_bf16 v249, v142, v207
    v_dot2c_f32_bf16 v248, v143, v143
    v_dot2c_f32_bf16 v249, v143, v207
    s_waitcnt vmcnt(9)
    ds_write_b128 v201, v[144:147] offset:128
    v_dot2c_f32_bf16 v248, v144, v144
    v_dot2c_f32_bf16 v249, v144, v207
    v_dot2c_f32_bf16 v248, v145, v145
    v_dot2c_f32_bf16 v249, v145, v207
    v_dot2c_f32_bf16 v248, v146, v146
    v_dot2c_f32_bf16 v249, v146, v207
    v_dot2c_f32_bf16 v248, v147, v147
    v_dot2c_f32_bf16 v249, v147, v207
    s_waitcnt vmcnt(8)
    ds_write_b128 v201, v[148:151] offset:160
    v_dot2c_f32_bf16 v248, v148, v148
    v_dot2c_f32_bf16 v249, v148, v207
    v_dot2c_f32_bf16 v248, v149, v149
    v_dot2c_f32_bf16 v249, v149, v207
    v_dot2c_f32_bf16 v248, v150, v150
    v_dot2c_f32_bf16 v249, v150, v207
    v_dot2c_f32_bf16 v248, v151, v151
    v_dot2c_f32_bf16 v249, v151, v207
    s_waitcnt vmcnt(7)
    ds_write_b128 v201, v[152:155] offset:192
    v_dot2c_f32_bf16 v248, v152, v152
    v_dot2c_f32_bf16 v249, v152, v207
    v_dot2c_f32_bf16 v248, v153, v153
    v_dot2c_f32_bf16 v249, v153, v207
    v_dot2c_f32_bf16 v248, v154, v154
    v_dot2c_f32_bf16 v249, v154, v207
    v_dot2c_f32_bf16 v248, v155, v155
    v_dot2c_f32_bf16 v249, v155, v207
    s_waitcnt vmcnt(6)
    ds_write_b128 v202, v[156:159] offset:0
    v_dot2c_f32_bf16 v250, v156, v156
    v_dot2c_f32_bf16 v251, v156, v207
    v_dot2c_f32_bf16 v250, v157, v157
    v_dot2c_f32_bf16 v251, v157, v207
    v_dot2c_f32_bf16 v250, v158, v158
    v_dot2c_f32_bf16 v251, v158, v207
    v_dot2c_f32_bf16 v250, v159, v159
    v_dot2c_f32_bf16 v251, v159, v207
    s_waitcnt vmcnt(5)
    ds_write_b128 v202, v[160:163] offset:32
    v_dot2c_f32_bf16 v250, v160, v160
    v_dot2c_f32_bf16 v251, v160, v207
    v_dot2c_f32_bf16 v250, v161, v161
    v_dot2c_f32_bf16 v251, v161, v207
    v_dot2c_f32_bf16 v250, v162, v162
    v_dot2c_f32_bf16 v251, v162, v207
    v_dot2c_f32_bf16 v250, v163, v163
    v_dot2c_f32_bf16 v251, v163, v207
    s_waitcnt vmcnt(4)
    ds_write_b128 v202, v[164:167] offset:64
    v_dot2c_f32_bf16 v250, v164, v164
    v_dot2c_f32_bf16 v251, v164, v207
    v_dot2c_f32_bf16 v250, v165, v165
    v_dot2c_f32_bf16 v251, v165, v207
    v_dot2c_f32_bf16 v250, v166, v166
    v_dot2c_f32_bf16 v251, v166, v207
    v_dot2c_f32_bf16 v250, v167, v167
    v_dot2c_f32_bf16 v251, v167, v207
    s_waitcnt vmcnt(3)
    ds_write_b128 v202, v[168:171] offset:96
    v_dot2c_f32_bf16 v250, v168, v168
    v_dot2c_f32_bf16 v251, v168, v207
    v_dot2c_f32_bf16 v250, v169, v169
    v_dot2c_f32_bf16 v251, v169, v207
    v_dot2c_f32_bf16 v250, v170, v170
    v_dot2c_f32_bf16 v251, v170, v207
    v_dot2c_f32_bf16 v250, v171, v171
    v_dot2c_f32_bf16 v251, v171, v207
    s_waitcnt vmcnt(2)
    ds_write_b128 v202, v[172:175] offset:128
    v_dot2c_f32_bf16 v250, v172, v172
    v_dot2c_f32_bf16 v251, v172, v207
    v_dot2c_f32_bf16 v250, v173, v173
    v_dot2c_f32_bf16 v251, v173, v207
    v_dot2c_f32_bf16 v250, v174, v174
    v_dot2c_f32_bf16 v251, v174, v207
    v_dot2c_f32_bf16 v250, v175, v175
    v_dot2c_f32_bf16 v251, v175, v207
    s_waitcnt vmcnt(1)
    ds_write_b128 v202, v[176:179] offset:160
    v_dot2c_f32_bf16 v250, v176, v176
    v_dot2c_f32_bf16 v251, v176, v207
    v_dot2c_f32_bf16 v250, v177, v177
    v_dot2c_f32_bf16 v251, v177, v207
    v_dot2c_f32_bf16 v250, v178, v178
    v_dot2c_f32_bf16 v251, v178, v207
    v_dot2c_f32_bf16 v250, v179, v179
    v_dot2c_f32_bf16 v251, v179, v207
    s_waitcnt vmcnt(0)
    ds_write_b128 v202, v[180:183] offset:192
    v_dot2c_f32_bf16 v250, v180, v180
    v_dot2c_f32_bf16 v251, v180, v207
    v_dot2c_f32_bf16 v250, v181, v181
    v_dot2c_f32_bf16 v251, v181, v207
    v_dot2c_f32_bf16 v250, v182, v182
    v_dot2c_f32_bf16 v251, v182, v207
    v_dot2c_f32_bf16 v250, v183, v183
    v_dot2c_f32_bf16 v251, v183, v207
    s_nop 1
    v_cndmask_b32 v252, v250, v248, s[0:1]
    v_cndmask_b32 v253, v248, v250, s[0:1]
    v_cndmask_b32 v254, v251, v249, s[0:1]
    v_cndmask_b32 v255, v249, v251, s[0:1]
    v_add_f32_dpp v253, v252, v253 row_half_mirror row_mask:0xf bank_mask:0xf
    s_nop 0
    v_add_f32_dpp v255, v254, v255 row_half_mirror row_mask:0xf bank_mask:0xf
    v_add_f32_dpp v253, v253, v253 quad_perm:[1,0,3,2] row_mask:0xf bank_mask:0xf
    s_nop 0
    v_add_f32_dpp v255, v255, v255 quad_perm:[1,0,3,2] row_mask:0xf bank_mask:0xf
    v_add_f32_dpp v253, v253, v253 quad_perm:[2,3,0,1] row_mask:0xf bank_mask:0xf
    s_nop 0
    v_add_f32_dpp v255, v255, v255 quad_perm:[2,3,0,1] row_mask:0xf bank_mask:0xf
    v_mul_f32 v255, 0xbb124925, v255
    v_mul_f32 v253, 0x3b124925, v253
    v_fma_f32 v253, -v255, v255, v253
    v_max_f32 v253, 0, v253
    v_add_f32 v253, 0x3727c5ac, v253
    v_rsq_f32 v253, v253
    v_cvt_pk_bf16_f32 v254, v255, v255
    s_mov_b32 exec_lo, s53
    s_mov_b32 exec_hi, s53
    ds_write_b32 v203, v253
    ds_write_b16 v204, v254 offset:256
    s_mov_b64 exec, -1
    s_waitcnt lgkmcnt(0)
    s_barrier
    ds_read_b128 v[112:115], v205 offset:0
    ds_read_b128 v[116:119], v205 offset:64
    ds_read_b128 v[120:123], v205 offset:128
    ds_read_b128 v[124:127], v205 offset:192
    ds_read_b128 v[192:195], v205 offset:256
    ds_read_b128 v[196:199], v205 offset:320
    ds_read_b64_tr_b16 v[128:129], v200 offset:0
    ds_read_b64_tr_b16 v[130:131], v200 offset:3584
    ds_read_b64_tr_b16 v[132:133], v200 offset:7168
    ds_read_b64_tr_b16 v[134:135], v200 offset:10752
    s_waitcnt lgkmcnt(9)
    v_pk_mul_f32 v[96:97], v[96:97], v[112:113]
    v_pk_mul_f32 v[98:99], v[98:99], v[114:115]
    v_cvt_pk_bf16_f32 v68, v96, v97
    v_cvt_pk_bf16_f32 v69, v98, v99
    ds_read_b64_tr_b16 v[136:137], v200 offset:32
    ds_read_b64_tr_b16 v[138:139], v200 offset:3616
    s_waitcnt lgkmcnt(10)
    v_pk_mul_f32 v[100:101], v[100:101], v[116:117]
    v_pk_mul_f32 v[102:103], v[102:103], v[118:119]
    v_cvt_pk_bf16_f32 v70, v100, v101
    v_cvt_pk_bf16_f32 v71, v102, v103
    ds_read_b64_tr_b16 v[140:141], v200 offset:7200
    ds_read_b64_tr_b16 v[142:143], v200 offset:10784
    s_waitcnt lgkmcnt(11)
    v_pk_mul_f32 v[104:105], v[104:105], v[120:121]
    v_pk_mul_f32 v[106:107], v[106:107], v[122:123]
    v_cvt_pk_bf16_f32 v72, v104, v105
    v_cvt_pk_bf16_f32 v73, v106, v107
    ds_read_b64_tr_b16 v[144:145], v200 offset:64
    ds_read_b64_tr_b16 v[146:147], v200 offset:3648
    s_waitcnt lgkmcnt(12)
    v_pk_mul_f32 v[108:109], v[108:109], v[124:125]
    v_pk_mul_f32 v[110:111], v[110:111], v[126:127]
    v_cvt_pk_bf16_f32 v74, v108, v109
    v_cvt_pk_bf16_f32 v75, v110, v111
    ds_read_b64_tr_b16 v[148:149], v200 offset:7232
    ds_read_b64_tr_b16 v[150:151], v200 offset:10816
    s_waitcnt lgkmcnt(12)
    v_mfma_f32_16x16x32_bf16 v[208:211], v[68:71], v[192:195], 0
    ds_read_b64_tr_b16 v[152:153], v200 offset:96
    ds_read_b64_tr_b16 v[154:155], v200 offset:3680
    v_mfma_f32_16x16x32_bf16 v[208:211], v[72:75], v[196:199], v[208:211]
    ds_read_b64_tr_b16 v[156:157], v200 offset:7264
    ds_read_b64_tr_b16 v[158:159], v200 offset:10848
    s_waitcnt lgkmcnt(12)
    v_mfma_f32_16x16x32_bf16 v[212:215], v[68:71], v[128:131], v[208:211]
    ds_read_b64_tr_b16 v[160:161], v200 offset:128
    ds_read_b64_tr_b16 v[162:163], v200 offset:3712
    v_mfma_f32_16x16x32_bf16 v[212:215], v[72:75], v[132:135], v[212:215]
    ds_read_b64_tr_b16 v[164:165], v200 offset:7296
    ds_read_b64_tr_b16 v[166:167], v200 offset:10880
    s_waitcnt lgkmcnt(12)
    v_mfma_f32_16x16x32_bf16 v[216:219], v[68:71], v[136:139], v[208:211]
    ds_read_b64_tr_b16 v[168:169], v200 offset:160
    ds_read_b64_tr_b16 v[170:171], v200 offset:3744
    v_mfma_f32_16x16x32_bf16 v[216:219], v[72:75], v[140:143], v[216:219]
    ds_read_b64_tr_b16 v[172:173], v200 offset:7328
    ds_read_b64_tr_b16 v[174:175], v200 offset:10912
    s_waitcnt lgkmcnt(12)
    v_mfma_f32_16x16x32_bf16 v[220:223], v[68:71], v[144:147], v[208:211]
    ds_read_b64_tr_b16 v[176:177], v200 offset:192
    ds_read_b64_tr_b16 v[178:179], v200 offset:3776
    v_mfma_f32_16x16x32_bf16 v[220:223], v[72:75], v[148:151], v[220:223]
    ds_read_b64_tr_b16 v[180:181], v200 offset:7360
    ds_read_b64_tr_b16 v[182:183], v200 offset:10944
    s_waitcnt lgkmcnt(12)
    v_mfma_f32_16x16x32_bf16 v[224:227], v[68:71], v[152:155], v[208:211]
    v_mfma_f32_16x16x32_bf16 v[224:227], v[72:75], v[156:159], v[224:227]
    s_waitcnt lgkmcnt(8)
    v_mfma_f32_16x16x32_bf16 v[228:231], v[68:71], v[160:163], v[208:211]
    v_cvt_pk_bf16_f32 v96, v212, v216
    v_cvt_pk_bf16_f32 v100, v213, v217
    v_mfma_f32_16x16x32_bf16 v[228:231], v[72:75], v[164:167], v[228:231]
    v_cvt_pk_bf16_f32 v104, v214, v218
    v_cvt_pk_bf16_f32 v108, v215, v219
    s_waitcnt lgkmcnt(4)
    v_mfma_f32_16x16x32_bf16 v[232:235], v[68:71], v[168:171], v[208:211]
    v_mfma_f32_16x16x32_bf16 v[232:235], v[72:75], v[172:175], v[232:235]
    s_waitcnt lgkmcnt(0)
    v_mfma_f32_16x16x32_bf16 v[236:239], v[68:71], v[176:179], v[208:211]
L_pad0:
    s_cbranch_execz L_pad4
    v_cvt_pk_bf16_f32 v97, v220, v224
    v_cvt_pk_bf16_f32 v101, v221, v225
    v_mfma_f32_16x16x32_bf16 v[236:239], v[72:75], v[180:183], v[236:239]
    v_cvt_pk_bf16_f32 v105, v222, v226
    v_cvt_pk_bf16_f32 v109, v223, v227
    s_nop 0
    v_cvt_pk_bf16_f32 v98, v228, v232
    v_cvt_pk_bf16_f32 v102, v229, v233
    v_cvt_pk_bf16_f32 v106, v230, v234
    v_cvt_pk_bf16_f32 v110, v231, v235
    s_nop 0
    v_cvt_pk_bf16_f32 v99, v236, s57
    buffer_store_dwordx4 v[96:99], v206, s[28:31], s44 offen sc1
    v_cvt_pk_bf16_f32 v103, v237, s57
    buffer_store_dwordx4 v[100:103], v206, s[28:31], s45 offen sc1
    v_cvt_pk_bf16_f32 v107, v238, s57
    buffer_store_dwordx4 v[104:107], v184, s[28:31], s44 offen sc1
    v_cvt_pk_bf16_f32 v111, v239, s57
    buffer_store_dwordx4 v[108:111], v184, s[28:31], s45 offen sc1
    s_lshl_b32 s44, s2, 7
    s_add_u32 s44, s44, 0x230000
    s_cmp_eq_u32 s20, 0
    s_cselect_b32 s44, s44, 0x40000000
    v_mov_b32 v64, s56
    v_lshlrev_b32 v65, 2, v1
    s_mov_b32 exec_hi, 0
    buffer_store_dword v64, v65, s[28:31], s44 offen sc1
    s_mov_b64 exec, -1
    s_and_b32 s55, s21, 0xfc
    s_cmp_eq_u32 s55, 4
    s_cselect_b32 s36, s54, s36
    s_cselect_b32 s37, 0, -1
    s_cselect_b32 s38, 0, 0xbe800000
    s_cmp_eq_u32 s55, 0
    s_cselect_b32 s39, 0, -1
    s_lshl_b32 s54, s20, 6
    s_add_u32 s48, s36, s54
    s_sub_u32 s49, 2048, s48
    s_cmp_eq_u32 s48, 0
    s_cselect_b32 s49, 1024, s49
    s_mul_i32 s48, s48, 896
    s_mul_i32 s49, s49, 896
    s_mul_i32 s50, s20, 1792
    s_add_u32 s50, s50, 147456
    v_lshlrev_b32 v2, 13, v5
    v_lshl_add_u32 v2, v7, 4, v2
    s_lshr_b32 s54, s21, 3
    s_lshl_b32 s54, s54, 16
    v_add_u32 v2, s54, v2
    s_lshl_b32 s54, s16, 11
    s_add_u32 s54, s54, 0x230000
    v_lshlrev_b32 v48, 7, v6
    v_add_u32 v48, s54, v48
L_join:
    v_lshrrev_b32 v92, 2, v6
    v_lshl_add_u32 v92, v92, 6, s36
    v_and_b32 v93, 3, v6
    s_cmp_eq_u32 s21, 0
    s_cselect_b32 s54, 2, 99
    v_cmp_eq_u32 s[64:65], s54, v6
    v_mov_b32 v94, 1024
    s_nop 0
    v_cndmask_b32 v92, v92, v94, s[64:65]
    v_cvt_f32_u32 v92, v92
    v_mul_f32 v92, 0x3a000000, v92
    v_cmp_eq_u32 vcc, 1, v93
    v_mov_b32 v94, 0x3e800000
    s_nop 0
    v_cndmask_b32 v94, 0, v94, vcc
    v_add_f32 v95, v42, v42
    v_fma_f32 v94, v92, v95, v94
    v_add_f32 v95, s38, v94
    v_cmp_gt_u32 vcc, 2, v93
    v_mov_b32 v66, s37
    v_mov_b32 v67, s39
    s_or_b64 s[64:65], s[64:65], vcc
    v_cndmask_b32 v67, 0, v67, vcc
    v_cndmask_b32 v66, 0, v66, s[64:65]
    s_bitcmp1_b32 s21, 1
    s_cselect_b64 vcc, -1, 0
    v_mov_b32 v93, v94
    v_cndmask_b32 v94, v94, v95, vcc
    v_cndmask_b32 v95, v95, v93, vcc
    v_mov_b32 v93, v66
    v_cndmask_b32 v66, v66, v67, vcc
    v_cndmask_b32 v67, v67, v93, vcc
    s_bitcmp1_b32 s21, 0
    s_cselect_b32 s54, 4.0, 0
    v_mul_f32 v93, s54, v92
    v_add_f32 v76, v94, v93
    v_sub_f32 v94, v94, v93
    v_fmamk_f32 v77, v92, 0x3f800000, v76
    v_fmamk_f32 v78, v92, 0x40000000, v76
    v_fmamk_f32 v79, v92, 0x40400000, v76
    v_fmamk_f32 v80, v92, 0x40800000, v94
    v_fmamk_f32 v81, v92, 0x40a00000, v94
    v_fmamk_f32 v82, v92, 0x40c00000, v94
    v_fmamk_f32 v83, v92, 0x40e00000, v94
    v_add_f32 v84, v95, v93
    v_sub_f32 v95, v95, v93
    v_fmamk_f32 v85, v92, 0x3f800000, v84
    v_fmamk_f32 v86, v92, 0x40000000, v84
    v_fmamk_f32 v87, v92, 0x40400000, v84
    v_fmamk_f32 v88, v92, 0x40800000, v95
    v_fmamk_f32 v89, v92, 0x40a00000, v95
    v_fmamk_f32 v90, v92, 0x40c00000, v95
    v_fmamk_f32 v91, v92, 0x40e00000, v95
    v_cos_f32 v76, v76
    v_cos_f32 v77, v77
    v_cos_f32 v78, v78
    v_cos_f32 v79, v79
    v_cos_f32 v80, v80
    v_cos_f32 v81, v81
    v_cos_f32 v82, v82
    v_cos_f32 v83, v83
    v_cos_f32 v84, v84
    v_cos_f32 v85, v85
    v_cos_f32 v86, v86
    v_cos_f32 v87, v87
    v_cos_f32 v88, v88
    v_cos_f32 v89, v89
    v_cos_f32 v90, v90
    v_cos_f32 v91, v91
    v_cvt_pk_bf16_f32 v8, v76, v77
    v_cvt_pk_bf16_f32 v9, v78, v79
    v_cvt_pk_bf16_f32 v10, v80, v81
    v_cvt_pk_bf16_f32 v11, v82, v83
    v_cvt_pk_bf16_f32 v12, v84, v85
    v_cvt_pk_bf16_f32 v13, v86, v87
    v_cvt_pk_bf16_f32 v14, v88, v89
    v_cvt_pk_bf16_f32 v15, v90, v91
    v_and_b32 v8, v66, v8
    v_and_b32 v9, v66, v9
    v_and_b32 v10, v66, v10
    v_and_b32 v11, v66, v11
    v_and_b32 v12, v67, v12
    v_and_b32 v13, v67, v13
    v_and_b32 v14, v67, v14
    v_and_b32 v15, v67, v15
    v_and_b32 v216, 2, v40
    v_xor_b32 v217, v41, v216
    v_mul_u32_u24 v38, 3584, v40
    v_lshl_add_u32 v38, v217, 4, v38
    v_xor_b32 v216, 64, v38
    s_mul_i32 s22, s17, 37
    s_lshr_b32 s22, s22, 8
    s_mul_i32 s54, s22, 7
    s_sub_u32 s19, s17, s54
    s_add_u32 s3, s54, s16
    s_add_u32 s55, s22, 28
    s_cmp_eq_u32 s16, 7
    s_cselect_b32 s3, s55, s3
    s_lshl_b32 s3, s3, 1
    s_and_b32 s54, s2, 1
    s_lshl2_add_u32 s22, s54, s22
    s_lshl2_add_u32 s55, s54, s19
    s_cmp_ge_u32 s17, 28
    s_cselect_b32 s55, s55, s19
    s_cselect_b32 s68, 1, 0
    s_cmp_eq_u32 s55, 7
    s_cselect_b32 s68, 2, s68
    s_cselect_b32 s55, 0, s55
    s_lshr_b32 s23, s16, 1
    s_mul_i32 s23, s23, 7
    s_add_u32 s23, s23, s55
    s_cmp_lt_u32 s20, 2
    s_cselect_b32 s32, s8, s10
    s_cselect_b32 s33, s9, s11
    s_and_b32 s33, s33, 0xffff
    s_mov_b32 s34, 1605632
    s_mov_b32 s35, 0x20000
    s_and_b32 s54, s20, 1
    s_mul_i32 s54, s54, 802816
    s_lshl_b32 s55, s23, 7
    s_add_u32 s18, s54, s55
    s_mul_i32 s15, s20, 28672
    s_mov_b32 s51, s18
    s_mov_b32 s52, s15
    s_add_u32 s46, s15, 28672
    s_and_b32 s54, s22, 3
    s_mul_i32 s54, s54, 7
    s_lshr_b32 s54, s54, 2
    s_mul_i32 s55, s54, 114688
    s_add_u32 s18, s18, s55
    s_lshl_b32 s55, s54, 12
    s_add_u32 s15, s15, s55
    v_add_u32 v240, 0, v38
    v_add_u32 v241, 27648, v216
    v_add_u32 v242, 55296, v38
    v_add_u32 v243, 82944, v216
    v_lshlrev_b32 v212, 12, v5
    v_and_b32 v213, 1, v5
    v_lshl_add_u32 v212, v213, 6, v212
    v_lshrrev_b32 v213, 1, v5
    v_lshl_add_u32 v212, v213, 4, v212
    v_add_u32 v212, 123380, v212
    v_mul_u32_u24 v213, 28, v7
    v_add_u32 v53, v212, v213
    v_cmp_eq_u32 vcc, 0, v7
    v_mov_b32 v214, 1792
    v_add_u32 v212, 2176, v212
    v_cndmask_b32 v214, 0, v214, vcc
    v_add_u32 v52, v53, v214
    s_cmp_eq_u32 s21, 0
    s_cselect_b32 s54, 0, 99
    v_cmp_eq_u32 vcc, s54, v5
    v_mov_b32 v215, 139796
    v_lshl_add_u32 v56, v5, 2, v213
    v_cndmask_b32 v212, v212, v215, vcc
    v_sub_u32 v55, v212, v213
    v_add_u32 v55, 1792, v55
    v_sub_u32 v54, v55, v214
    v_sub_u32 v57, 127360, v56
    v_add_u32 v56, 125568, v56
    v_lshlrev_b32 v60, 9, v40
    v_lshl_add_u32 v60, v41, 4, v60
    s_lshr_b32 s54, s21, 2
    s_mul_i32 s54, s54, 28672
    s_and_b32 s55, s21, 3
    s_lshl_b32 s55, s55, 7
    s_add_u32 s54, s54, s55
    s_mul_i32 s55, s20, 7168
    s_add_u32 s54, s54, s55
    v_add_u32 v60, s54, v60
    s_mov_b32 s40, s62
    s_and_b32 s41, s63, 0xffff
    s_mov_b32 s42, 0x1c0000
    s_mov_b32 s43, 0x20000
    s_mov_b32 s36, s12
    s_and_b32 s37, s13, 0xffff
    s_mov_b32 s38, 0x188000
    s_mov_b32 s39, 0x20000
    s_mov_b32 s60, 0x05040100
    s_mov_b32 s61, 0x07060302
    s_mov_b32 s62, 0x3f1f9d07
    s_mov_b32 s63, 0xbe63dc87
    s_mov_b32 s64, 0xbf66a5e5
    s_mov_b32 s65, 0x3f48261c
    s_mov_b32 s66, 0x3f7994e0
    s_mov_b32 s67, 0x3ede2602
    s_and_b32 s4, s21, 1
    s_lshl_b32 s4, s4, 12
    s_and_b32 s5, s21, 2
    s_lshl_b32 s5, s5, 14
    s_or_b32 s53, s4, s5
    s_xor_b32 s4, s53, 4096
    s_xor_b32 s5, s53, 32768
    s_xor_b32 s6, s53, 36864
    s_mov_b32 s7, 0x200000
    v_mov_b32 v200, s58
    v_mov_b32 v204, s58
    v_mov_b32 v208, s58
    s_mov_b32 s59, 0xffff
    s_mov_b32 s69, 0
    s_cmp_lg_u32 s20, 3
    s_cbranch_scc1 L_pw1
    s_mov_b32 s55, 0
    s_mov_b64 exec, 0xffff
    s_branch L_probe1a
L_probea:
    s_sleep 2
L_probe1a:
    buffer_load_dword v64, v48, s[28:31], 0 offen sc1
    s_add_u32 s55, s55, 1
    s_waitcnt vmcnt(0)
    v_cmp_eq_u32 vcc, s56, v64
    s_cmp_gt_u32 s55, 400000
    s_cbranch_scc1 L_probe2a
    s_bcnt1_i32_b32 s54, vcc_lo
    s_cmp_lt_u32 s54, 3
    s_cbranch_scc1 L_probea
L_probe2a:
    s_mov_b64 exec, -1
    s_barrier
    s_cmp_ge_u32 s54, 8
    s_cbranch_scc1 L_probe2b
    s_mov_b32 s55, 0
    s_mov_b64 exec, 0xffff
    s_branch L_probe1b
L_probeb:
    s_sleep 2
L_probe1b:
    buffer_load_dword v64, v48, s[28:31], 0 offen sc1
    s_add_u32 s55, s55, 1
    s_waitcnt vmcnt(0)
    v_cmp_eq_u32 vcc, s56, v64
    s_cmp_gt_u32 s55, 400000
    s_cbranch_scc1 L_probe2b
    s_bcnt1_i32_b32 s54, vcc_lo
    s_cmp_lt_u32 s54, 8
    s_cbranch_scc1 L_probeb
L_probe2b:
    s_mov_b64 exec, -1
L_pw1:
    s_barrier
    s_cmp_lg_u32 s21, 0
    s_cbranch_scc1 L_nosa
    buffer_load_dword v192, v3, s[28:31], s7 offen offset:0 sc1
    buffer_load_dword v193, v3, s[28:31], s7 offen offset:256 sc1
    buffer_load_dword v194, v3, s[28:31], s7 offen offset:512 sc1
    buffer_load_dword v195, v3, s[28:31], s7 offen offset:768 sc1
    buffer_load_dword v196, v3, s[28:31], s7 offen offset:1024 sc1
    buffer_load_dword v197, v3, s[28:31], s7 offen offset:1280 sc1
    buffer_load_dword v198, v3, s[28:31], s7 offen offset:1536 sc1
L_nosa:
    s_mov_b64 exec, 0xfffffff
    buffer_load_dwordx4 v[200:203], v47, s[28:31], s7 offen offset:0 sc1
    buffer_load_dwordx4 v[204:207], v47, s[28:31], s7 offen offset:1792 sc1
    buffer_load_dwordx4 v[208:211], v47, s[28:31], s7 offen offset:3584 sc1
    s_mov_b64 exec, -1
    buffer_load_dword v184, v3, s[28:31], s7 offen offset:1792 sc1
    buffer_load_dword v185, v3, s[28:31], s7 offen offset:2048 sc1
    buffer_load_dword v186, v3, s[28:31], s7 offen offset:2304 sc1
    buffer_load_dword v187, v3, s[28:31], s7 offen offset:2560 sc1
    buffer_load_dword v188, v3, s[28:31], s7 offen offset:2816 sc1
    buffer_load_dword v189, v3, s[28:31], s7 offen offset:3072 sc1
    buffer_load_dword v190, v3, s[28:31], s7 offen offset:3328 sc1
    s_cmp_eq_u32 s20, 3
    s_cbranch_scc1 L_pw2
    s_barrier
L_pw2:
    buffer_load_dwordx4 v[64:67], v2, s[28:31], s53 offen offset:0 sc1
    buffer_load_dwordx4 v[68:71], v2, s[28:31], s53 offen offset:1024 sc1
    buffer_load_dwordx4 v[72:75], v2, s[28:31], s53 offen offset:2048 sc1
    buffer_load_dwordx4 v[76:79], v2, s[28:31], s53 offen offset:3072 sc1
    s_waitcnt vmcnt(4)
    v_xor_b32 v253, s58, v184
    v_bitop3_b32 v253, v185, s58, v253 bitop3:0xbe
    v_bitop3_b32 v253, v186, s58, v253 bitop3:0xbe
    v_bitop3_b32 v253, v187, s58, v253 bitop3:0xbe
    buffer_load_dwordx4 v[80:83], v2, s[28:31], s4 offen offset:0 sc1
    v_bitop3_b32 v253, v188, s58, v253 bitop3:0xbe
    v_bitop3_b32 v253, v189, s58, v253 bitop3:0xbe
    v_bitop3_b32 v253, v190, s58, v253 bitop3:0xbe
    v_bitop3_b32 v253, v200, s58, v253 bitop3:0xbe
    v_bitop3_b32 v253, v204, s58, v253 bitop3:0xbe
    buffer_load_dwordx4 v[84:87], v2, s[28:31], s4 offen offset:1024 sc1
    v_bitop3_b32 v253, v208, s58, v253 bitop3:0xbe
    v_lshlrev_b32 v253, 16, v253
    v_cmp_ne_u32 s[16:17], 0, v253
    v_and_b32 v244, 0xffff0000, v200
    v_and_b32 v245, 0xffff0000, v201
    buffer_load_dwordx4 v[88:91], v2, s[28:31], s4 offen offset:2048 sc1
    v_and_b32 v246, 0xffff0000, v202
    v_and_b32 v247, 0xffff0000, v203
    ds_write_b128 v44, v[244:247] offset:0
    v_and_b32 v184, 0xffff0000, v184
    v_and_b32 v185, 0xffff0000, v185
    buffer_load_dwordx4 v[92:95], v2, s[28:31], s4 offen offset:3072 sc1
    v_and_b32 v186, 0xffff0000, v186
    v_and_b32 v244, 0xffff0000, v204
    v_and_b32 v245, 0xffff0000, v205
    v_and_b32 v246, 0xffff0000, v206
    v_and_b32 v247, 0xffff0000, v207
    buffer_load_dwordx4 v[96:99], v2, s[28:31], s5 offen offset:0 sc1
    v_mul_f32 v244, 0x3eeff558, v244
    v_mul_f32 v245, 0x3eeff558, v245
    v_mul_f32 v246, 0x3eeff558, v246
    v_mul_f32 v247, 0x3eeff558, v247
    ds_write_b128 v44, v[244:247] offset:512
    buffer_load_dwordx4 v[100:103], v2, s[28:31], s5 offen offset:1024 sc1
    v_and_b32 v187, 0xffff0000, v187
    v_and_b32 v188, 0xffff0000, v188
    v_and_b32 v189, 0xffff0000, v189
    v_and_b32 v244, 0xffff0000, v208
    v_and_b32 v245, 0xffff0000, v209
    buffer_load_dwordx4 v[104:107], v2, s[28:31], s5 offen offset:2048 sc1
    v_and_b32 v246, 0xffff0000, v210
    v_and_b32 v247, 0xffff0000, v211
    ds_write_b128 v44, v[244:247] offset:1024
    v_and_b32 v190, 0xffff0000, v190
    s_or_b32 s14, s16, s17
    buffer_load_dwordx4 v[108:111], v2, s[28:31], s5 offen offset:3072 sc1
    buffer_load_dwordx4 v[112:115], v2, s[28:31], s6 offen offset:0 sc1
    buffer_load_dwordx4 v[116:119], v2, s[28:31], s6 offen offset:1024 sc1
    buffer_load_dwordx4 v[120:123], v2, s[28:31], s6 offen offset:2048 sc1
    buffer_load_dwordx4 v[124:127], v2, s[28:31], s6 offen offset:3072 sc1
    s_mov_b32 m0, s50
    s_mov_b32 exec_hi, 0xffffff
    buffer_load_dwordx4 v4, s[24:27], s48 offen lds
    s_add_u32 m0, s50, 896
    s_nop 0
    buffer_load_dwordx4 v4, s[24:27], s49 offen lds
    s_mov_b64 exec, -1
    s_waitcnt vmcnt(16)
    v_xor_b32 v252, s57, v67
    v_bitop3_b32 v252, v71, s57, v252 bitop3:0xbe
    v_cmp_lt_u32 s[0:1], s59, v252
    v_perm_b32 v128, v68, v64, s60
    v_perm_b32 v132, v68, v64, s61
    v_perm_b32 v136, v69, v65, s60
    v_perm_b32 v140, v69, v65, s61
    v_perm_b32 v144, v70, v66, s60
    v_perm_b32 v148, v70, v66, s61
    v_perm_b32 v152, v71, v67, s60
    s_waitcnt vmcnt(14)
    v_xor_b32 v252, s57, v75
    v_bitop3_b32 v252, v79, s57, v252 bitop3:0xbe
    v_cmp_lt_u32 s[8:9], s59, v252
    v_perm_b32 v129, v76, v72, s60
    v_perm_b32 v133, v76, v72, s61
    v_perm_b32 v137, v77, v73, s60
    v_perm_b32 v141, v77, v73, s61
    v_perm_b32 v145, v78, v74, s60
    v_perm_b32 v149, v78, v74, s61
    v_perm_b32 v153, v79, v75, s60
    s_waitcnt vmcnt(12)
    v_xor_b32 v252, s57, v83
    v_bitop3_b32 v252, v87, s57, v252 bitop3:0xbe
    v_cmp_lt_u32 s[10:11], s59, v252
    v_perm_b32 v130, v84, v80, s60
    v_perm_b32 v134, v84, v80, s61
    v_perm_b32 v138, v85, v81, s60
    v_perm_b32 v142, v85, v81, s61
    v_perm_b32 v146, v86, v82, s60
    v_perm_b32 v150, v86, v82, s61
    v_perm_b32 v154, v87, v83, s60
    s_waitcnt vmcnt(10)
    v_xor_b32 v252, s57, v91
    v_bitop3_b32 v252, v95, s57, v252 bitop3:0xbe
    v_cmp_lt_u32 s[12:13], s59, v252
    v_perm_b32 v131, v92, v88, s60
    v_perm_b32 v135, v92, v88, s61
    v_perm_b32 v139, v93, v89, s60
    v_perm_b32 v143, v93, v89, s61
    v_perm_b32 v147, v94, v90, s60
    v_perm_b32 v151, v94, v90, s61
    v_perm_b32 v155, v95, v91, s60
    s_waitcnt vmcnt(8)
    v_xor_b32 v252, s57, v99
    v_bitop3_b32 v252, v103, s57, v252 bitop3:0xbe
    v_cmp_lt_u32 s[44:45], s59, v252
    v_perm_b32 v212, v100, v96, s60
    v_perm_b32 v216, v100, v96, s61
    v_perm_b32 v220, v101, v97, s60
    v_perm_b32 v224, v101, v97, s61
    v_perm_b32 v228, v102, v98, s60
    v_perm_b32 v232, v102, v98, s61
    v_perm_b32 v236, v103, v99, s60
    v_mfma_f32_16x16x32_bf16 v[156:159], v[8:11], v[128:131], 0
    v_mfma_f32_16x16x32_bf16 v[160:163], v[8:11], v[132:135], 0
    v_mfma_f32_16x16x32_bf16 v[164:167], v[8:11], v[136:139], 0
    s_waitcnt vmcnt(6)
    v_xor_b32 v252, s57, v107
    v_bitop3_b32 v252, v111, s57, v252 bitop3:0xbe
    v_cmp_lt_u32 s[54:55], s59, v252
    v_perm_b32 v213, v108, v104, s60
    v_perm_b32 v217, v108, v104, s61
    v_perm_b32 v221, v109, v105, s60
    v_perm_b32 v225, v109, v105, s61
    v_perm_b32 v229, v110, v106, s60
    v_perm_b32 v233, v110, v106, s61
    v_perm_b32 v237, v111, v107, s60
    v_mfma_f32_16x16x32_bf16 v[168:171], v[8:11], v[140:143], 0
    v_mfma_f32_16x16x32_bf16 v[172:175], v[8:11], v[144:147], 0
    s_waitcnt vmcnt(4)
    v_xor_b32 v252, s57, v115
    v_bitop3_b32 v252, v119, s57, v252 bitop3:0xbe
    v_cmp_lt_u32 s[100:101], s59, v252
    v_perm_b32 v214, v116, v112, s60
    v_perm_b32 v218, v116, v112, s61
    v_perm_b32 v222, v117, v113, s60
    v_perm_b32 v226, v117, v113, s61
    v_perm_b32 v230, v118, v114, s60
    v_perm_b32 v234, v118, v114, s61
    v_perm_b32 v238, v119, v115, s60
    v_mfma_f32_16x16x32_bf16 v[176:179], v[8:11], v[148:151], 0
    v_mfma_f32_16x16x32_bf16 v[180:183], v[8:11], v[152:155], 0
    s_or_b64 s[16:17], s[0:1], s[8:9]
    s_or_b32 s16, s16, s14
    s_or_b64 s[16:17], s[16:17], s[10:11]
    s_or_b64 s[16:17], s[16:17], s[12:13]
    s_or_b64 s[16:17], s[16:17], s[44:45]
    s_or_b64 s[16:17], s[16:17], s[54:55]
    s_or_b64 s[16:17], s[16:17], s[100:101]
    s_waitcnt vmcnt(2)
    v_xor_b32 v252, s57, v123
    v_bitop3_b32 v252, v127, s57, v252 bitop3:0xbe
    v_cmp_lt_u32 vcc, s59, v252
    v_perm_b32 v215, v124, v120, s60
    v_perm_b32 v219, v124, v120, s61
    v_perm_b32 v223, v125, v121, s60
    v_perm_b32 v227, v125, v121, s61
    v_perm_b32 v231, v126, v122, s60
    v_perm_b32 v235, v126, v122, s61
    v_perm_b32 v239, v127, v123, s60
L_ks1:
    v_mfma_f32_16x16x32_bf16 v[156:159], v[12:15], v[212:215], v[156:159]
    v_mfma_f32_16x16x32_bf16 v[160:163], v[12:15], v[216:219], v[160:163]
    s_or_b64 s[16:17], s[16:17], vcc
    s_cbranch_scc1 L_uretry
L_uok:
    v_mfma_f32_16x16x32_bf16 v[164:167], v[12:15], v[220:223], v[164:167]
    s_mov_b32 m0, s15
    s_add_u32 s15, s15, 4096
    buffer_load_dwordx4 v240, s[32:35], s18 offen offset:0 lds
    v_mfma_f32_16x16x32_bf16 v[168:171], v[12:15], v[224:227], v[168:171]
    buffer_load_dwordx4 v241, s[32:35], s18 offen offset:1024 lds
    v_mfma_f32_16x16x32_bf16 v[172:175], v[12:15], v[228:231], v[172:175]
    buffer_load_dwordx4 v242, s[32:35], s18 offen offset:2048 lds
    v_mfma_f32_16x16x32_bf16 v[176:179], v[12:15], v[232:235], v[176:179]
    buffer_load_dwordx4 v243, s[32:35], s18 offen offset:3072 lds
    v_mfma_f32_16x16x32_bf16 v[180:183], v[12:15], v[236:239], v[180:183]
    s_add_u32 s18, s18, 114688
    s_cmp_eq_u32 s15, s46
    s_cselect_b32 s15, s52, s15
    s_cselect_b32 s18, s51, s18
    s_mov_b32 m0, s15
    s_add_u32 s15, s15, 4096
    buffer_load_dwordx4 v240, s[32:35], s18 offen offset:0 lds
    s_lshl_b32 s55, s2, 2
    s_add_u32 s55, s55, s20
    s_mul_i32 s55, s55, 1664
    v_lshlrev_b32 v253, 7, v1
    s_mov_b64 exec, 0x1fff
    buffer_load_dword v255, v253, s[36:39], s55 offen
    s_mov_b64 exec, -1
    v_pk_mul_f32 v[156:157], v[156:157], v[184:185] op_sel:[0,0] op_sel_hi:[1,0]
    v_pk_mul_f32 v[160:161], v[160:161], v[184:185] op_sel:[0,1] op_sel_hi:[1,1]
    v_pk_mul_f32 v[164:165], v[164:165], v[186:187] op_sel:[0,0] op_sel_hi:[1,0]
    v_pk_mul_f32 v[168:169], v[168:169], v[186:187] op_sel:[0,1] op_sel_hi:[1,1]
    v_pk_mul_f32 v[172:173], v[172:173], v[188:189] op_sel:[0,0] op_sel_hi:[1,0]
    v_pk_mul_f32 v[176:177], v[176:177], v[188:189] op_sel:[0,1] op_sel_hi:[1,1]
    v_pk_mul_f32 v[180:181], v[180:181], v[190:191] op_sel:[0,0] op_sel_hi:[1,0]
    s_cmp_eq_u32 s21, 0
    s_cbranch_scc1 L_spec1
L_spec1_ret:
    v_pk_add_f32 v[128:129], v[160:161], v[180:181]
    v_pk_add_f32 v[134:135], v[160:161], v[180:181] neg_lo:[0,1] neg_hi:[0,1]
    v_pk_add_f32 v[130:131], v[164:165], v[176:177]
    v_pk_add_f32 v[136:137], v[164:165], v[176:177] neg_lo:[0,1] neg_hi:[0,1]
    v_pk_add_f32 v[132:133], v[168:169], v[172:173]
    v_pk_add_f32 v[138:139], v[168:169], v[172:173] neg_lo:[0,1] neg_hi:[0,1]
    v_pk_add_f32 v[152:153], v[156:157], v[128:129]
    v_pk_add_f32 v[154:155], v[130:131], v[132:133]
    v_pk_add_f32 v[152:153], v[152:153], v[154:155]
    v_cvt_pk_bf16_f32 v152, v152, v153
    ds_write_b32 v49, v152 offset:816
    v_pk_fma_f32 v[140:141], v[128:129], s[62:63], v[156:157] op_sel:[0,0,0] op_sel_hi:[1,0,1]
    v_pk_mul_f32 v[146:147], v[134:135], s[64:65] op_sel:[0,1] op_sel_hi:[1,1]
    v_pk_fma_f32 v[140:141], v[130:131], s[62:63], v[140:141] op_sel:[0,1,0] op_sel_hi:[1,1,1]
    v_pk_fma_f32 v[146:147], v[136:137], s[66:67], v[146:147] op_sel:[0,0,0] op_sel_hi:[1,0,1]
    v_pk_fma_f32 v[140:141], v[132:133], s[64:65], v[140:141] op_sel:[0,0,0] op_sel_hi:[1,0,1]
    v_pk_fma_f32 v[146:147], v[138:139], s[66:67], v[146:147] op_sel:[0,1,0] op_sel_hi:[1,1,1]
    v_pk_add_f32 v[96:97], v[140:141], v[146:147] op_sel:[0,1] op_sel_hi:[1,0] neg_hi:[0,1]
    v_pk_add_f32 v[98:99], v[140:141], v[146:147] op_sel:[0,1] op_sel_hi:[1,0] neg_lo:[0,1]
    v_pk_mul_f32 v[100:101], v[96:97], v[32:33] op_sel:[0,0] op_sel_hi:[1,0]
    v_pk_mul_f32 v[102:103], v[98:99], v[32:33] op_sel:[0,0] op_sel_hi:[1,0]
    v_pk_fma_f32 v[100:101], v[96:97], v[32:33], v[100:101] op_sel:[1,1,0] op_sel_hi:[0,1,1] neg_hi:[1,0,0]
    v_pk_fma_f32 v[102:103], v[98:99], v[32:33], v[102:103] op_sel:[1,1,0] op_sel_hi:[0,1,1] neg_lo:[1,0,0]
    v_cvt_pk_bf16_f32 v100, v100, v101
    v_cvt_pk_bf16_f32 v102, v102, v103
    ds_write_b32 v49, v100 offset:4352
    ds_write_b32 v49, v102 offset:544
    buffer_load_dwordx4 v241, s[32:35], s18 offen offset:1024 lds
    v_pk_fma_f32 v[142:143], v[128:129], s[62:63], v[156:157] op_sel:[0,1,0] op_sel_hi:[1,1,1]
    v_pk_mul_f32 v[148:149], v[134:135], s[66:67] op_sel:[0,0] op_sel_hi:[1,0]
    v_pk_fma_f32 v[142:143], v[130:131], s[64:65], v[142:143] op_sel:[0,0,0] op_sel_hi:[1,0,1]
    v_pk_fma_f32 v[148:149], v[136:137], s[66:67], v[148:149] op_sel:[0,1,0] op_sel_hi:[1,1,1] neg_lo:[1,0,0] neg_hi:[1,0,0]
    v_pk_fma_f32 v[142:143], v[132:133], s[62:63], v[142:143] op_sel:[0,0,0] op_sel_hi:[1,0,1]
    v_pk_fma_f32 v[148:149], v[138:139], s[64:65], v[148:149] op_sel:[0,1,0] op_sel_hi:[1,1,1] neg_lo:[1,0,0] neg_hi:[1,0,0]
    v_pk_add_f32 v[104:105], v[142:143], v[148:149] op_sel:[0,1] op_sel_hi:[1,0] neg_hi:[0,1]
    v_pk_add_f32 v[106:107], v[142:143], v[148:149] op_sel:[0,1] op_sel_hi:[1,0] neg_lo:[0,1]
    v_pk_mul_f32 v[108:109], v[104:105], v[34:35] op_sel:[0,0] op_sel_hi:[1,0]
    v_pk_mul_f32 v[110:111], v[106:107], v[34:35] op_sel:[0,0] op_sel_hi:[1,0]
    v_pk_fma_f32 v[108:109], v[104:105], v[34:35], v[108:109] op_sel:[1,1,0] op_sel_hi:[0,1,1] neg_hi:[1,0,0]
    v_pk_fma_f32 v[110:111], v[106:107], v[34:35], v[110:111] op_sel:[1,1,0] op_sel_hi:[0,1,1] neg_lo:[1,0,0]
    v_cvt_pk_bf16_f32 v108, v108, v109
    v_cvt_pk_bf16_f32 v110, v110, v111
    ds_write_b32 v49, v108 offset:4624
    ds_write_b32 v49, v110 offset:272
    buffer_load_dwordx4 v242, s[32:35], s18 offen offset:2048 lds
    v_pk_fma_f32 v[144:145], v[128:129], s[64:65], v[156:157] op_sel:[0,0,0] op_sel_hi:[1,0,1]
    v_pk_mul_f32 v[150:151], v[134:135], s[66:67] op_sel:[0,1] op_sel_hi:[1,1]
    v_pk_fma_f32 v[144:145], v[130:131], s[62:63], v[144:145] op_sel:[0,0,0] op_sel_hi:[1,0,1]
    v_pk_fma_f32 v[150:151], v[136:137], s[64:65], v[150:151] op_sel:[0,1,0] op_sel_hi:[1,1,1] neg_lo:[1,0,0] neg_hi:[1,0,0]
    v_pk_fma_f32 v[144:145], v[132:133], s[62:63], v[144:145] op_sel:[0,1,0] op_sel_hi:[1,1,1]
    v_pk_fma_f32 v[150:151], v[138:139], s[66:67], v[150:151] op_sel:[0,0,0] op_sel_hi:[1,0,1]
    v_pk_add_f32 v[112:113], v[144:145], v[150:151] op_sel:[0,1] op_sel_hi:[1,0] neg_hi:[0,1]
    v_pk_add_f32 v[114:115], v[144:145], v[150:151] op_sel:[0,1] op_sel_hi:[1,0] neg_lo:[0,1]
    v_pk_mul_f32 v[116:117], v[112:113], v[36:37] op_sel:[0,0] op_sel_hi:[1,0]
    v_pk_mul_f32 v[118:119], v[114:115], v[36:37] op_sel:[0,0] op_sel_hi:[1,0]
    v_pk_fma_f32 v[116:117], v[112:113], v[36:37], v[116:117] op_sel:[1,1,0] op_sel_hi:[0,1,1] neg_hi:[1,0,0]
    v_pk_fma_f32 v[118:119], v[114:115], v[36:37], v[118:119] op_sel:[1,1,0] op_sel_hi:[0,1,1] neg_lo:[1,0,0]
    v_cvt_pk_bf16_f32 v116, v116, v117
    v_cvt_pk_bf16_f32 v118, v118, v119
    ds_write_b32 v49, v116 offset:4896
    ds_write_b32 v49, v118 offset:0
    buffer_load_dwordx4 v243, s[32:35], s18 offen offset:3072 lds
    s_add_u32 s18, s18, 114688
    s_cmp_eq_u32 s15, s46
    s_cselect_b32 s15, s52, s15
    s_cselect_b32 s18, s51, s18
    s_waitcnt vmcnt(9)
    s_waitcnt lgkmcnt(0)
    s_barrier
    ds_read_b128 v[64:67], v50 offset:0
    ds_read_b128 v[80:83], v50 offset:4352
    ds_read_b128 v[68:71], v50 offset:64
    ds_read_b128 v[84:87], v50 offset:4416
    ds_read_b128 v[72:75], v50 offset:128
    ds_read_b128 v[88:91], v50 offset:4480
    ds_read_b128 v[76:79], v50 offset:192
    ds_read_b128 v[92:95], v50 offset:4544
    s_waitcnt lgkmcnt(7)
    v_mfma_f32_16x16x32_bf16 v[96:99], v[64:67], v[16:19], 0
    s_waitcnt lgkmcnt(6)
    v_mfma_f32_16x16x32_bf16 v[100:103], v[80:83], v[16:19], 0
    s_waitcnt lgkmcnt(5)
    v_mfma_f32_16x16x32_bf16 v[96:99], v[68:71], v[20:23], v[96:99]
    ds_read_b128 v[144:147], v43 offset:0
    s_waitcnt lgkmcnt(5)
    v_mfma_f32_16x16x32_bf16 v[100:103], v[84:87], v[20:23], v[100:103]
    ds_read_b128 v[148:151], v43 offset:128
    s_waitcnt lgkmcnt(5)
    v_mfma_f32_16x16x32_bf16 v[96:99], v[72:75], v[24:27], v[96:99]
    ds_read_b128 v[192:195], v45 offset:0
    s_waitcnt lgkmcnt(5)
    v_mfma_f32_16x16x32_bf16 v[100:103], v[88:91], v[24:27], v[100:103]
    ds_read_b128 v[196:199], v45 offset:16
    s_waitcnt lgkmcnt(5)
    v_mfma_f32_16x16x32_bf16 v[96:99], v[76:79], v[28:31], v[96:99]
    ds_read_b128 v[200:203], v45 offset:256
    s_waitcnt lgkmcnt(5)
    v_mfma_f32_16x16x32_bf16 v[100:103], v[92:95], v[28:31], v[100:103]
    ds_read_b128 v[204:207], v45 offset:272
    s_nop 3
    ds_write2_b32 v52, v96, v97 offset0:0 offset1:1
    ds_write2_b32 v54, v97, v96 offset0:5 offset1:6
    ds_write_b32 v52, v98 offset:8
    ds_write2_b32 v54, v99, v98 offset0:3 offset1:4
    ds_write2_b32 v53, v99, v100 offset0:3 offset1:4
    ds_write2_b32 v55, v101, v100 offset0:1 offset1:2
    ds_write2_b32 v53, v101, v102 offset0:5 offset1:6
    ds_write_b32 v55, v102
    s_cmp_eq_u32 s21, 0
    s_cbranch_scc1 L_spec2
L_spec2_ret:
    s_waitcnt lgkmcnt(12)
    v_lshlrev_b32 v128, 16, v144
    v_and_b32 v129, 0xffff0000, v144
    v_lshlrev_b32 v130, 16, v145
    v_and_b32 v131, 0xffff0000, v145
    v_lshlrev_b32 v132, 16, v146
    v_and_b32 v133, 0xffff0000, v146
    v_lshlrev_b32 v134, 16, v147
    v_and_b32 v135, 0xffff0000, v147
    v_lshlrev_b32 v136, 16, v148
    v_and_b32 v137, 0xffff0000, v148
    v_lshlrev_b32 v138, 16, v149
    v_and_b32 v139, 0xffff0000, v149
L_pad1:
    s_cbranch_execz L_pad5
    v_lshlrev_b32 v140, 16, v150
    v_and_b32 v141, 0xffff0000, v150
    v_lshlrev_b32 v142, 16, v151
    v_and_b32 v143, 0xffff0000, v151
    s_waitcnt lgkmcnt(0)
    s_barrier
    ds_read_b128 v[64:67], v51 offset:0
    ds_read_b128 v[68:71], v51 offset:16
    ds_read_b128 v[72:75], v51 offset:256
    ds_read_b128 v[76:79], v51 offset:272
    s_waitcnt lgkmcnt(2)
    v_pk_fma_f32 v[64:65], v[64:65], v[192:193], v[128:129]
    v_pk_fma_f32 v[66:67], v[66:67], v[194:195], v[130:131]
    v_pk_fma_f32 v[68:69], v[68:69], v[196:197], v[132:133]
    v_pk_fma_f32 v[70:71], v[70:71], v[198:199], v[134:135]
    v_pk_add_f32 v[80:81], v[64:65], v[66:67]
    v_pk_mul_f32 v[82:83], v[64:65], v[64:65]
    v_pk_fma_f32 v[82:83], v[66:67], v[66:67], v[82:83]
    v_pk_add_f32 v[80:81], v[80:81], v[68:69]
    v_pk_fma_f32 v[82:83], v[68:69], v[68:69], v[82:83]
    v_pk_add_f32 v[80:81], v[80:81], v[70:71]
    v_pk_fma_f32 v[82:83], v[70:71], v[70:71], v[82:83]
    s_waitcnt lgkmcnt(0)
    s_mov_b32 exec_hi, 0xffff
    v_pk_fma_f32 v[72:73], v[72:73], v[200:201], v[136:137]
    v_pk_fma_f32 v[74:75], v[74:75], v[202:203], v[138:139]
    v_pk_fma_f32 v[76:77], v[76:77], v[204:205], v[140:141]
    v_pk_fma_f32 v[78:79], v[78:79], v[206:207], v[142:143]
    v_pk_add_f32 v[80:81], v[80:81], v[72:73]
    v_pk_fma_f32 v[82:83], v[72:73], v[72:73], v[82:83]
    v_pk_add_f32 v[80:81], v[80:81], v[74:75]
    v_pk_fma_f32 v[82:83], v[74:75], v[74:75], v[82:83]
    v_pk_add_f32 v[80:81], v[80:81], v[76:77]
    v_pk_fma_f32 v[82:83], v[76:77], v[76:77], v[82:83]
    v_pk_add_f32 v[80:81], v[80:81], v[78:79]
    v_pk_fma_f32 v[82:83], v[78:79], v[78:79], v[82:83]
    s_mov_b64 exec, -1
    v_add_f32 v80, v80, v81
    v_add_f32 v82, v82, v83
    ds_read_b128 v[208:211], v45 offset:512
    v_add_f32_dpp v80, v80, v80 row_ror:8 row_mask:0xf bank_mask:0xf
    v_add_f32_dpp v82, v82, v82 row_ror:8 row_mask:0xf bank_mask:0xf
    ds_read_b128 v[212:215], v45 offset:528
    ds_read_b128 v[216:219], v45 offset:768
    v_permlane16_swap_b32 v80, v82
    v_add_f32 v80, v80, v82
    v_mov_b32 v82, v80
    ds_read_b128 v[220:223], v45 offset:784
    ds_read_b128 v[224:227], v45 offset:1024
    v_permlane32_swap_b32 v80, v82
    v_add_f32 v80, v80, v82
    s_mov_b64 exec, 0x00ff00ff
    ds_write_b32 v58, v80
    s_mov_b64 exec, -1
    ds_read_b128 v[228:231], v45 offset:1040
    ds_read_b128 v[232:235], v45 offset:1280
    ds_read_b128 v[236:239], v45 offset:1296
    s_waitcnt lgkmcnt(3)
    s_barrier
    ds_read_b128 v[84:87], v59
    ds_read_b128 v[88:91], v59 offset:16
    v_mov_b32 v92, 0x4091afa4
    s_mov_b32 s4, 0x300000
    s_mov_b32 s5, 0x301000
    s_mov_b32 s6, 0x500000
    s_mov_b32 s101, 0x501000
    v_cvt_pk_bf16_f32 v128, v64, v65
    v_cvt_pk_bf16_f32 v129, v66, v67
    v_cvt_pk_bf16_f32 v130, v68, v69
    v_cvt_pk_bf16_f32 v131, v70, v71
    v_cvt_pk_bf16_f32 v132, v72, v73
    v_cvt_pk_bf16_f32 v133, v74, v75
    v_cvt_pk_bf16_f32 v134, v76, v77
    v_cvt_pk_bf16_f32 v135, v78, v79
    s_waitcnt lgkmcnt(0)
    v_pk_add_f32 v[84:85], v[84:85], v[86:87]
    v_pk_add_f32 v[88:89], v[88:89], v[90:91]
    v_add_f32 v84, v84, v85
    v_add_f32 v88, v88, v89
    v_mul_f32 v85, 0xbb124925, v84
    v_mul_f32 v88, 0x3b124925, v88
    v_fma_f32 v88, -v85, v85, v88
    v_max_f32 v88, 0, v88
    v_fmaak_f32 v88, v88, v92, 0x383ef424
    v_rsq_f32 v84, v88
    s_nop 0
    v_mul_f32 v85, v85, v84
    v_pk_fma_f32 v[64:65], v[64:65], v[84:85], v[84:85] op_sel:[0,0,1] op_sel_hi:[1,0,1]
    v_pk_fma_f32 v[66:67], v[66:67], v[84:85], v[84:85] op_sel:[0,0,1] op_sel_hi:[1,0,1]
    v_pk_fma_f32 v[68:69], v[68:69], v[84:85], v[84:85] op_sel:[0,0,1] op_sel_hi:[1,0,1]
    v_pk_fma_f32 v[70:71], v[70:71], v[84:85], v[84:85] op_sel:[0,0,1] op_sel_hi:[1,0,1]
    v_pk_fma_f32 v[64:65], v[64:65], v[224:225], v[208:209]
    v_pk_fma_f32 v[66:67], v[66:67], v[226:227], v[210:211]
    v_pk_fma_f32 v[68:69], v[68:69], v[228:229], v[212:213]
    v_pk_fma_f32 v[70:71], v[70:71], v[230:231], v[214:215]
    v_cvt_pk_bf16_f32 v96, v64, v65
    v_cvt_pk_bf16_f32 v97, v66, v67
    v_cvt_pk_bf16_f32 v98, v68, v69
    v_cvt_pk_bf16_f32 v99, v70, v71
    buffer_store_dwordx4 v[96:99], v60, s[28:31], s4 offen sc1
    v_pk_fma_f32 v[72:73], v[72:73], v[84:85], v[84:85] op_sel:[0,0,1] op_sel_hi:[1,0,1]
    v_pk_fma_f32 v[74:75], v[74:75], v[84:85], v[84:85] op_sel:[0,0,1] op_sel_hi:[1,0,1]
    v_pk_fma_f32 v[76:77], v[76:77], v[84:85], v[84:85] op_sel:[0,0,1] op_sel_hi:[1,0,1]
    v_pk_fma_f32 v[78:79], v[78:79], v[84:85], v[84:85] op_sel:[0,0,1] op_sel_hi:[1,0,1]
    v_pk_fma_f32 v[72:73], v[72:73], v[232:233], v[216:217]
    v_pk_fma_f32 v[74:75], v[74:75], v[234:235], v[218:219]
    v_pk_fma_f32 v[76:77], v[76:77], v[236:237], v[220:221]
    v_pk_fma_f32 v[78:79], v[78:79], v[238:239], v[222:223]
    v_cvt_pk_bf16_f32 v100, v72, v73
    v_cvt_pk_bf16_f32 v101, v74, v75
    v_cvt_pk_bf16_f32 v102, v76, v77
    v_cvt_pk_bf16_f32 v103, v78, v79
    s_mov_b32 exec_hi, 0xffff
    buffer_store_dwordx4 v[100:103], v60, s[28:31], s5 offen sc1
    s_mov_b64 exec, -1
    s_mov_b32 m0, s15
    s_add_u32 s15, s15, 4096
    buffer_load_dwordx4 v240, s[32:35], s18 offen offset:0 lds
    s_lshl_b32 s59, s21, 7
    s_add_u32 s45, s59, 0x240000
    s_add_u32 s59, s59, 0x210000
    v_lshlrev_b32 v237, 2, v1
    v_mov_b32 v238, s56
    s_lshr_b32 s7, s23, 2
    s_mul_i32 s60, s22, 7
    s_sub_u32 s60, s60, s7
    s_add_u32 s61, s60, 1
    s_sub_u32 s4, 63, s7
    buffer_load_dwordx4 v241, s[32:35], s18 offen offset:1024 lds
    s_sub_u32 s5, 56, s7
    s_cmp_eq_u32 s68, 0
    s_cselect_b32 s1, s60, s5
    s_cselect_b32 s60, s60, s4
    s_cselect_b32 s61, s61, s5
    s_cselect_b32 s4, 27, 31
    s_lshl_b32 s1, s1, 2
    v_min_u32 v235, s4, v1
    v_add_u32 v235, s1, v235
    v_and_b32 v235, 0xff, v235
    s_mov_b32 s1, 0x210000
    v_lshlrev_b32 v235, 7, v235
    s_add_u32 s62, s61, 1
    s_add_u32 s63, s61, 2
    buffer_load_dwordx4 v242, s[32:35], s18 offen offset:2048 lds
    s_add_u32 s64, s61, 3
    s_add_u32 s65, s61, 4
    s_add_u32 s66, s61, 5
    s_and_b32 s60, s60, 63
    s_mul_i32 s60, s60, 28672
    s_and_b32 s61, s61, 63
    s_mul_i32 s61, s61, 28672
    s_and_b32 s62, s62, 63
    s_mul_i32 s62, s62, 28672
    s_and_b32 s63, s63, 63
    buffer_load_dwordx4 v243, s[32:35], s18 offen offset:3072 lds
    s_mul_i32 s63, s63, 28672
    s_and_b32 s64, s64, 63
    s_mul_i32 s64, s64, 28672
    s_and_b32 s65, s65, 63
    s_mul_i32 s65, s65, 28672
    s_and_b32 s66, s66, 63
    s_mul_i32 s66, s66, 28672
    s_mul_i32 s53, s20, 7168
    s_add_u32 s4, s53, 0x300000
    v_add_u32 v232, s4, v4
    s_add_u32 s18, s18, 114688
    s_cmp_eq_u32 s15, s46
    s_cselect_b32 s15, s52, s15
    s_cselect_b32 s18, s51, s18
    s_mov_b32 m0, s15
    s_add_u32 s15, s15, 4096
    buffer_load_dwordx4 v240, s[32:35], s18 offen offset:0 lds
    v_add_u32 v233, 4096, v232
    v_lshlrev_b32 v251, 9, v5
    v_lshl_add_u32 v251, v6, 4, v251
    v_add_u32 v13, 114688, v251
    v_mov_b32 v236, 0xfffefffe
    s_and_b32 s44, s56, 0x10001
    v_mov_b32 v250, 0x3e6050f9
    v_and_b32 v16, 1, v5
    v_add_u32 v16, -1, v16
    v_and_b32 v249, s44, v16
    buffer_load_dwordx4 v241, s[32:35], s18 offen offset:1024 lds
    s_lshl_b32 s67, s20, 12
    s_add_u32 s4, s67, 57344
    v_add_u32 v244, s4, v62
    v_xor_b32 v245, 32, v244
    v_xor_b32 v246, 64, v244
    v_xor_b32 v247, 96, v244
    v_add_u32 v28, 73728, v244
    v_add_u32 v29, 73728, v245
    v_add_u32 v30, 73728, v246
    v_add_u32 v31, 73728, v247
    s_waitcnt vmcnt(6)
    s_barrier
    s_cmp_lg_u32 s20, 0
    s_cbranch_scc1 L_nofl
    s_mov_b32 exec_hi, 0
    buffer_store_dword v238, v237, s[28:31], s59 offen sc1
    s_mov_b64 exec, -1
L_nofl:
    buffer_load_dwordx4 v242, s[32:35], s18 offen offset:2048 lds
    v_lshrrev_b32 v16, 1, v5
    v_mul_u32_u24 v16, 3072, v16
    v_add_u32 v16, v16, v251
    v_add_u32 v24, 0, v16
    v_add_u32 v25, 8192, v16
    v_add_u32 v26, 114688, v16
    v_add_u32 v27, 122880, v16
    v_and_b32 v239, 7, v1
    s_lshl_b32 s47, s3, 9
    v_lshlrev_b32 v239, 7, v239
    buffer_load_dwordx4 v243, s[32:35], s18 offen offset:3072 lds
    s_add_u32 s47, s47, 0x240000
    s_sub_u32 s55, 63, s3
    s_mul_i32 s54, s55, 37
    s_lshr_b32 s54, s54, 8
    s_mul_i32 s54, s54, 7
    s_sub_u32 s55, s55, s54
    s_mul_i32 s5, s3, 114688
    s_lshl_b32 s7, s20, 10
    s_add_u32 s5, s5, s7
    s_add_u32 s100, s5, 0x700000
    s_add_u32 s18, s18, 114688
    s_cmp_eq_u32 s15, s46
    s_cselect_b32 s15, s52, s15
    s_cselect_b32 s18, s51, s18
    s_mov_b32 m0, s15
    s_add_u32 s15, s15, 4096
    buffer_load_dwordx4 v240, s[32:35], s18 offen offset:0 lds
    s_lshl_b32 s8, s55, 14
    s_add_u32 s55, s55, 1
    s_cmp_eq_u32 s55, 7
    s_cselect_b32 s55, 0, s55
    s_lshl_b32 s9, s55, 14
    s_add_u32 s55, s55, 1
    s_cmp_eq_u32 s55, 7
    s_cselect_b32 s55, 0, s55
    s_lshl_b32 s10, s55, 14
    s_add_u32 s55, s55, 1
    s_cmp_eq_u32 s55, 7
    s_cselect_b32 s55, 0, s55
    s_lshl_b32 s11, s55, 14
    buffer_load_dwordx4 v241, s[32:35], s18 offen offset:1024 lds
    s_add_u32 s55, s55, 1
    s_cmp_eq_u32 s55, 7
    s_cselect_b32 s55, 0, s55
    s_lshl_b32 s12, s55, 14
    s_add_u32 s55, s55, 1
    s_cmp_eq_u32 s55, 7
    s_cselect_b32 s55, 0, s55
    s_lshl_b32 s13, s55, 14
    s_add_u32 s55, s55, 1
    s_cmp_eq_u32 s55, 7
    s_cselect_b32 s55, 0, s55
    s_lshl_b32 s14, s55, 14
    s_lshl_b32 s5, s20, 10
    buffer_load_dwordx4 v242, s[32:35], s18 offen offset:2048 lds
    s_add_u32 s4, s5, 114688
    s_add_u32 s5, s5, 0x300000
    s_add_u32 s5, s5, s60
    buffer_load_dwordx4 v243, s[32:35], s18 offen offset:3072 lds
    s_add_u32 s18, s18, 114688
    s_cmp_eq_u32 s15, s46
    s_cselect_b32 s15, s52, s15
    s_cselect_b32 s18, s51, s18
    s_mov_b32 m0, s15
    s_add_u32 s15, s15, 4096
    buffer_load_dwordx4 v240, s[32:35], s18 offen offset:0 lds
    buffer_load_dwordx4 v241, s[32:35], s18 offen offset:1024 lds
    buffer_load_dwordx4 v242, s[32:35], s18 offen offset:2048 lds
    buffer_load_dwordx4 v243, s[32:35], s18 offen offset:3072 lds
    s_add_u32 s18, s18, 114688
    s_cmp_eq_u32 s15, s46
    s_cselect_b32 s15, s52, s15
    s_cselect_b32 s18, s51, s18
    s_mov_b32 m0, s15
    s_add_u32 s15, s15, 4096
    buffer_load_dwordx4 v240, s[32:35], s18 offen offset:0 lds
    buffer_load_dwordx4 v241, s[32:35], s18 offen offset:1024 lds
    buffer_load_dwordx4 v242, s[32:35], s18 offen offset:2048 lds
    buffer_load_dwordx4 v243, s[32:35], s18 offen offset:3072 lds
    s_cmp_lg_u32 s68, 0
    s_cbranch_scc1 L_lsetup
L_lsetup_ret:
    s_mov_b32 s15, s53
    s_lshl_b32 s18, s23, 2
    s_add_u32 s18, s18, s20
    s_lshl_b32 s18, s18, 10
    s_add_u32 s18, s18, 0x700000
    v_mov_b32 v240, v61
    v_xor_b32 v243, 64, v61
    v_add_u32 v241, 6144, v243
    v_add_u32 v242, 55296, v61
    v_add_u32 v243, 61440, v243
    s_mul_i32 s55, s20, 14336
    s_lshl_b32 s7, s19, 7
    s_add_u32 s55, s55, s7
    s_mul_i32 s7, s8, 14
    s_add_u32 s48, s7, s55
    s_add_u32 s8, s8, s100
    s_mul_i32 s7, s9, 14
    s_add_u32 s49, s7, s55
    s_add_u32 s9, s9, s100
    s_mul_i32 s7, s10, 14
    s_add_u32 s50, s7, s55
    s_add_u32 s10, s10, s100
    s_mul_i32 s7, s11, 14
    s_add_u32 s51, s7, s55
    s_add_u32 s11, s11, s100
    s_mul_i32 s7, s12, 14
    s_add_u32 s52, s7, s55
    s_add_u32 s12, s12, s100
    s_mul_i32 s7, s13, 14
    s_add_u32 s53, s7, s55
    s_add_u32 s13, s13, s100
    s_mul_i32 s7, s14, 14
    s_add_u32 s54, s7, s55
    s_add_u32 s14, s14, s100
    v_and_b32 v252, 7, v1
    v_lshlrev_b32 v252, 5, v252
    s_lshl_b32 s55, s19, 8
    s_add_u32 s55, s55, 0x202300
    buffer_load_dwordx4 v[16:19], v252, s[28:31], s55 offen offset:0 sc1
    buffer_load_dwordx4 v[20:23], v252, s[28:31], s55 offen offset:16 sc1
    s_add_u32 m0, s67, 147456
    s_add_u32 s7, s54, 0
    buffer_load_dwordx4 v240, s[36:39], s7 offen offset:0 lds
    buffer_load_dwordx4 v241, s[36:39], s7 offen offset:1024 lds
    buffer_load_dwordx4 v242, s[36:39], s7 offen offset:2048 lds
    buffer_load_dwordx4 v243, s[36:39], s7 offen offset:3072 lds
    s_waitcnt vmcnt(6)
    s_barrier
    ds_read_b64_tr_b16 a[0:1], v39 offset:0
    ds_read_b64_tr_b16 a[2:3], v39 offset:512
    ds_read_b64_tr_b16 a[4:5], v63 offset:0
    ds_read_b64_tr_b16 a[6:7], v63 offset:512
    ds_read_b64_tr_b16 a[8:9], v39 offset:4096
    buffer_load_dword v234, v235, s[28:31], s1 offen sc1
    ds_read_b64_tr_b16 a[10:11], v39 offset:4608
    ds_read_b64_tr_b16 a[12:13], v63 offset:4096
    ds_read_b64_tr_b16 a[14:15], v63 offset:4608
    ds_read_b64_tr_b16 a[16:17], v39 offset:8192
    ds_read_b64_tr_b16 a[18:19], v39 offset:8704
    ds_read_b64_tr_b16 a[20:21], v63 offset:8192
    ds_read_b64_tr_b16 a[22:23], v63 offset:8704
    ds_read_b64_tr_b16 a[24:25], v39 offset:12288
    ds_read_b64_tr_b16 a[26:27], v39 offset:12800
    ds_read_b64_tr_b16 a[28:29], v63 offset:12288
    ds_read_b64_tr_b16 a[30:31], v63 offset:12800
    ds_read_b64_tr_b16 a[32:33], v39 offset:16384
    ds_read_b64_tr_b16 a[34:35], v39 offset:16896
    ds_read_b64_tr_b16 a[36:37], v63 offset:16384
    ds_read_b64_tr_b16 a[38:39], v63 offset:16896
    ds_read_b64_tr_b16 a[40:41], v39 offset:20480
    ds_read_b64_tr_b16 a[42:43], v39 offset:20992
    ds_read_b64_tr_b16 a[44:45], v63 offset:20480
    ds_read_b64_tr_b16 a[46:47], v63 offset:20992
    ds_read_b64_tr_b16 a[48:49], v39 offset:24576
    ds_read_b64_tr_b16 a[50:51], v39 offset:25088
    ds_read_b64_tr_b16 a[52:53], v63 offset:24576
    ds_read_b64_tr_b16 a[54:55], v63 offset:25088
    ds_read_b64_tr_b16 a[56:57], v39 offset:28672
    ds_read_b64_tr_b16 a[58:59], v39 offset:29184
    ds_read_b64_tr_b16 a[60:61], v63 offset:28672
    ds_read_b64_tr_b16 a[62:63], v63 offset:29184
    ds_read_b64_tr_b16 a[64:65], v39 offset:32768
    ds_read_b64_tr_b16 a[66:67], v39 offset:33280
    ds_read_b64_tr_b16 a[68:69], v63 offset:32768
    ds_read_b64_tr_b16 a[70:71], v63 offset:33280
    ds_read_b64_tr_b16 a[72:73], v39 offset:36864
    ds_read_b64_tr_b16 a[74:75], v39 offset:37376
    ds_read_b64_tr_b16 a[76:77], v63 offset:36864
    ds_read_b64_tr_b16 a[78:79], v63 offset:37376
    ds_read_b64_tr_b16 a[80:81], v39 offset:40960
    ds_read_b64_tr_b16 a[82:83], v39 offset:41472
    ds_read_b64_tr_b16 a[84:85], v63 offset:40960
    ds_read_b64_tr_b16 a[86:87], v63 offset:41472
    ds_read_b64_tr_b16 a[88:89], v39 offset:45056
    ds_read_b64_tr_b16 a[90:91], v39 offset:45568
    ds_read_b64_tr_b16 a[92:93], v63 offset:45056
    ds_read_b64_tr_b16 a[94:95], v63 offset:45568
    ds_read_b64_tr_b16 a[96:97], v39 offset:49152
    ds_read_b64_tr_b16 a[98:99], v39 offset:49664
    ds_read_b64_tr_b16 a[100:101], v63 offset:49152
    ds_read_b64_tr_b16 a[102:103], v63 offset:49664
    ds_read_b64_tr_b16 a[104:105], v39 offset:53248
    ds_read_b64_tr_b16 a[106:107], v39 offset:53760
    ds_read_b64_tr_b16 a[108:109], v63 offset:53248
    ds_read_b64_tr_b16 a[110:111], v63 offset:53760
    v_lshrrev_b32 v2, 3, v1
    v_and_b32 v3, 7, v1
    v_lshlrev_b32 v5, 9, v2
    v_lshl_add_u32 v5, v3, 4, v5
    v_lshlrev_b32 v6, 5, v3
    v_lshl_add_u32 v6, v2, 2, v6
    s_mul_i32 s46, s3, 28672
    s_lshl_b32 s21, s19, 12
    s_add_u32 s46, s46, s21
    s_lshl_b32 s21, s20, 7
    s_add_u32 s46, s46, s21
    s_add_u32 s46, s46, 0x500000
    s_add_u32 s21, s46, 28672
    s_mov_b32 s69, 0
    s_waitcnt vmcnt(0)
    s_branch L_fl1
L_fl:
    buffer_load_dword v234, v235, s[28:31], s1 offen sc1
    s_waitcnt vmcnt(0)
L_fl1:
    s_add_u32 s69, s69, 1
    s_cmp_gt_u32 s69, 400000
    v_cmpx_ne_u32 vcc, s56, v234
    s_cbranch_scc1 L_fl2
    s_cbranch_execnz L_fl
L_fl2:
    s_mov_b64 exec, -1
    s_add_u32 m0, s4, 0
    s_add_u32 s7, s5, 0
    buffer_load_dwordx4 v4, s[28:31], s7 offen sc1 lds
    s_add_u32 m0, s4, 4096
    s_add_u32 s7, s5, 4096
    buffer_load_dwordx4 v4, s[28:31], s7 offen sc1 lds
    s_add_u32 m0, s4, 8192
    s_add_u32 s7, s5, 8192
    buffer_load_dwordx4 v4, s[28:31], s7 offen sc1 lds
    s_add_u32 m0, s4, 12288
    s_add_u32 s7, s5, 12288
    buffer_load_dwordx4 v4, s[28:31], s7 offen sc1 lds
    s_add_u32 m0, s4, 16384
    s_add_u32 s7, s5, 16384
    buffer_load_dwordx4 v4, s[28:31], s7 offen sc1 lds
    s_add_u32 m0, s4, 20480
    s_add_u32 s7, s5, 20480
    buffer_load_dwordx4 v4, s[28:31], s7 offen sc1 lds
    s_add_u32 m0, s4, 24576
    s_add_u32 s7, s5, 24576
    buffer_load_dwordx4 v4, s[28:31], s7 offen sc1 lds
    v_xor_b32 v253, s58, v16
    v_bitop3_b32 v253, v20, s58, v253 bitop3:0xbe
    v_lshlrev_b32 v253, 16, v253
    v_cmp_ne_u32 vcc, 0, v253
    s_nop 0
    s_cbranch_vccnz L_gb
L_gb_ret:
    v_and_b32 v16, 0xffff0000, v16
    v_and_b32 v17, 0xffff0000, v17
    v_and_b32 v18, 0xffff0000, v18
    v_and_b32 v19, 0xffff0000, v19
    v_and_b32 v20, 0xffff0000, v20
    v_and_b32 v21, 0xffff0000, v21
    v_and_b32 v22, 0xffff0000, v22
    v_and_b32 v23, 0xffff0000, v23
    v_and_b32 v253, 1, v2
    v_cmp_eq_u32 s[16:17], 1, v253
    v_mov_b32 v254, 1024
    s_lshl2_add_u32 s23, s3, s20
    s_add_u32 s23, s23, 0
    s_lshr_b32 s22, s23, 3
    s_and_b32 s100, s23, 7
    s_lshl_b32 s100, s100, 8
    s_add_u32 s22, s22, s100
    s_sub_u32 s100, s22, 992
    s_and_b32 s23, s23, 0xfc
    s_cmp_eq_u32 s23, 4
    s_cselect_b32 s22, s100, s22
    v_lshrrev_b32 v7, 1, v2
    v_lshl_add_u32 v7, v7, 6, s22
    v_cmp_eq_u32 vcc, 0, v7
    v_sub_u32 v253, 2048, v7
    s_nop 0
    v_cndmask_b32 v253, v253, v254, vcc
    v_cndmask_b32 v7, v7, v253, s[16:17]
    v_mul_u32_u24 v7, 896, v7
    v_lshl_add_u32 v7, v3, 4, v7
    s_lshl2_add_u32 s23, s3, s20
    s_add_u32 s23, s23, 4
    s_lshr_b32 s22, s23, 3
    s_and_b32 s100, s23, 7
    s_lshl_b32 s100, s100, 8
    s_add_u32 s22, s22, s100
    s_sub_u32 s100, s22, 992
    s_and_b32 s23, s23, 0xfc
    s_cmp_eq_u32 s23, 4
    s_cselect_b32 s22, s100, s22
    v_lshrrev_b32 v0, 1, v2
    v_lshl_add_u32 v0, v0, 6, s22
    v_cmp_eq_u32 vcc, 0, v0
    v_sub_u32 v253, 2048, v0
    s_nop 0
    v_cndmask_b32 v253, v253, v254, vcc
    v_cndmask_b32 v0, v0, v253, s[16:17]
    v_mul_u32_u24 v0, 896, v0
    v_lshl_add_u32 v0, v3, 4, v0
    s_lshl_b32 s100, s19, 7
    v_lshrrev_b32 v253, 5, v1
    v_lshlrev_b32 v253, 6, v253
    v_xor_b32 v248, v4, v253
    s_lshl_b32 s23, s20, 13
    v_add_u32 v248, s23, v248
    v_xor_b32 v255, 128, v248
    s_and_b32 s23, s20, 1
    s_lshl_b32 s23, s23, 3
    v_add_u32 v15, s23, v2
    v_and_b32 v253, 3, v3
    v_lshlrev_b32 v253, 2, v253
    v_xor_b32 v15, v15, v253
    v_lshlrev_b32 v15, 4, v15
    v_lshl_add_u32 v15, v3, 9, v15
    s_lshr_b32 s23, s20, 1
    s_lshl_b32 s23, s23, 12
    v_add_u32 v15, s23, v15
    s_waitcnt vmcnt(5)
    s_waitcnt lgkmcnt(0)
    s_barrier
    s_cmp_lg_u32 s68, 0
    s_cbranch_scc1 L_long
    ds_read_b128 v[64:67], v13 offset:0
    ds_read_b128 v[68:71], v13 offset:256
    ds_read_b128 v[72:75], v13 offset:2048
    ds_read_b128 v[76:79], v13 offset:2304
    ds_read_b128 v[80:83], v13 offset:4096
    ds_read_b128 v[84:87], v13 offset:4352
    ds_read_b128 v[88:91], v13 offset:6144
    s_add_u32 m0, s15, 0
    s_nop 0
    buffer_load_dwordx4 v232, s[28:31], s61 offen offset:0 sc1 lds
    buffer_load_dwordx4 v232, s[28:31], s61 offen offset:1024 sc1 lds
    buffer_load_dwordx4 v232, s[28:31], s61 offen offset:2048 sc1 lds
    buffer_load_dwordx4 v232, s[28:31], s61 offen offset:3072 sc1 lds
    s_waitcnt lgkmcnt(3)
    v_mfma_f32_16x16x32_bf16 v[96:99], a[0:3], v[64:67], 0
    ds_read_b128 v[92:95], v13 offset:6400
    v_mfma_f32_16x16x32_bf16 v[100:103], a[4:7], v[64:67], 0
    s_waitcnt vmcnt(8)
    s_barrier
    s_add_u32 m0, s15, 4096
    v_mfma_f32_16x16x32_bf16 v[104:107], a[0:3], v[68:71], 0
    ds_read_b128 v[64:67], v13 offset:8192
    v_mfma_f32_16x16x32_bf16 v[108:111], a[4:7], v[68:71], 0
    buffer_load_dwordx4 v233, s[28:31], s61 offen offset:0 sc1 lds
    v_mfma_f32_16x16x32_bf16 v[96:99], a[8:11], v[72:75], v[96:99]
    ds_read_b128 v[68:71], v13 offset:8448
    v_add_u32 v14, 0, v251
    v_mfma_f32_16x16x32_bf16 v[100:103], a[12:15], v[72:75], v[100:103]
    v_mfma_f32_16x16x32_bf16 v[104:107], a[8:11], v[76:79], v[104:107]
    ds_read_b128 v[72:75], v13 offset:10240
    v_mfma_f32_16x16x32_bf16 v[108:111], a[12:15], v[76:79], v[108:111]
    buffer_load_dwordx4 v233, s[28:31], s61 offen offset:1024 sc1 lds
    s_waitcnt lgkmcnt(3)
    v_mfma_f32_16x16x32_bf16 v[96:99], a[16:19], v[80:83], v[96:99]
    ds_read_b128 v[76:79], v13 offset:10496
    v_mfma_f32_16x16x32_bf16 v[100:103], a[20:23], v[80:83], v[100:103]
    s_waitcnt vmcnt(9)
    s_barrier
    v_mfma_f32_16x16x32_bf16 v[104:107], a[16:19], v[84:87], v[104:107]
    ds_read_b128 v[80:83], v13 offset:12288
    v_mfma_f32_16x16x32_bf16 v[108:111], a[20:23], v[84:87], v[108:111]
    buffer_load_dwordx4 v233, s[28:31], s61 offen offset:2048 sc1 lds
    v_mfma_f32_16x16x32_bf16 v[96:99], a[24:27], v[88:91], v[96:99]
    ds_read_b128 v[84:87], v13 offset:12544
    v_mfma_f32_16x16x32_bf16 v[100:103], a[28:31], v[88:91], v[100:103]
    v_mfma_f32_16x16x32_bf16 v[104:107], a[24:27], v[92:95], v[104:107]
    ds_read_b128 v[88:91], v13 offset:14336
    v_mfma_f32_16x16x32_bf16 v[108:111], a[28:31], v[92:95], v[108:111]
    buffer_store_dwordx4 v[128:131], v60, s[28:31], s6 offen sc1
    s_waitcnt lgkmcnt(3)
    v_mfma_f32_16x16x32_bf16 v[96:99], a[32:35], v[64:67], v[96:99]
    ds_read_b128 v[92:95], v13 offset:14592
    v_mfma_f32_16x16x32_bf16 v[100:103], a[36:39], v[64:67], v[100:103]
    s_waitcnt vmcnt(10)
    s_barrier
    v_mfma_f32_16x16x32_bf16 v[104:107], a[32:35], v[68:71], v[104:107]
    ds_read_b128 v[64:67], v13 offset:16384
    v_mfma_f32_16x16x32_bf16 v[108:111], a[36:39], v[68:71], v[108:111]
    s_mov_b32 exec_hi, 0xffff
    buffer_store_dwordx4 v[132:135], v60, s[28:31], s101 offen sc1
    s_mov_b64 exec, -1
    s_nop 0
    v_mfma_f32_16x16x32_bf16 v[96:99], a[40:43], v[72:75], v[96:99]
    ds_read_b128 v[68:71], v13 offset:16640
    v_mfma_f32_16x16x32_bf16 v[100:103], a[44:47], v[72:75], v[100:103]
    s_add_u32 m0, s15, 28672
    v_mfma_f32_16x16x32_bf16 v[104:107], a[40:43], v[76:79], v[104:107]
    ds_read_b128 v[72:75], v13 offset:18432
    ds_read_b64_tr_b16 a[112:113], v28 offset:16384
    v_mfma_f32_16x16x32_bf16 v[108:111], a[44:47], v[76:79], v[108:111]
    buffer_load_dwordx4 v232, s[28:31], s62 offen offset:0 sc1 lds
    s_waitcnt lgkmcnt(4)
    v_mfma_f32_16x16x32_bf16 v[96:99], a[48:51], v[80:83], v[96:99]
    ds_read_b128 v[76:79], v13 offset:18688
    ds_read_b64_tr_b16 a[114:115], v28 offset:16896
    v_mfma_f32_16x16x32_bf16 v[100:103], a[52:55], v[80:83], v[100:103]
    s_waitcnt vmcnt(11)
    s_barrier
    v_mfma_f32_16x16x32_bf16 v[104:107], a[48:51], v[84:87], v[104:107]
    ds_read_b128 v[80:83], v13 offset:20480
    ds_read_b64_tr_b16 a[116:117], v29 offset:16384
    v_mfma_f32_16x16x32_bf16 v[108:111], a[52:55], v[84:87], v[108:111]
    buffer_load_dwordx4 v232, s[28:31], s62 offen offset:1024 sc1 lds
    v_mfma_f32_16x16x32_bf16 v[96:99], a[56:59], v[88:91], v[96:99]
    ds_read_b128 v[84:87], v13 offset:20736
    ds_read_b64_tr_b16 a[118:119], v29 offset:16896
    v_mfma_f32_16x16x32_bf16 v[100:103], a[60:63], v[88:91], v[100:103]
    v_mfma_f32_16x16x32_bf16 v[104:107], a[56:59], v[92:95], v[104:107]
    ds_read_b128 v[88:91], v13 offset:22528
    ds_read_b64_tr_b16 a[120:121], v30 offset:16384
    v_mfma_f32_16x16x32_bf16 v[108:111], a[60:63], v[92:95], v[108:111]
    buffer_load_dwordx4 v232, s[28:31], s62 offen offset:2048 sc1 lds
    s_waitcnt lgkmcnt(7)
    v_mfma_f32_16x16x32_bf16 v[96:99], a[64:67], v[64:67], v[96:99]
    ds_read_b128 v[92:95], v13 offset:22784
    ds_read_b64_tr_b16 a[122:123], v30 offset:16896
    v_mfma_f32_16x16x32_bf16 v[100:103], a[68:71], v[64:67], v[100:103]
    s_waitcnt vmcnt(12)
    s_barrier
    v_mfma_f32_16x16x32_bf16 v[104:107], a[64:67], v[68:71], v[104:107]
    ds_read_b128 v[64:67], v13 offset:24576
    ds_read_b64_tr_b16 a[124:125], v31 offset:16384
    v_mfma_f32_16x16x32_bf16 v[108:111], a[68:71], v[68:71], v[108:111]
    buffer_load_dwordx4 v232, s[28:31], s62 offen offset:3072 sc1 lds
    v_mfma_f32_16x16x32_bf16 v[96:99], a[72:75], v[72:75], v[96:99]
    ds_read_b128 v[68:71], v13 offset:24832
    ds_read_b64_tr_b16 a[126:127], v31 offset:16896
    v_mfma_f32_16x16x32_bf16 v[100:103], a[76:79], v[72:75], v[100:103]
    s_add_u32 m0, s15, 32768
    v_mfma_f32_16x16x32_bf16 v[104:107], a[72:75], v[76:79], v[104:107]
    ds_read_b128 v[72:75], v13 offset:26624
    v_mfma_f32_16x16x32_bf16 v[108:111], a[76:79], v[76:79], v[108:111]
    buffer_load_dwordx4 v233, s[28:31], s62 offen offset:0 sc1 lds
    s_waitcnt lgkmcnt(6)
    v_mfma_f32_16x16x32_bf16 v[96:99], a[80:83], v[80:83], v[96:99]
    ds_read_b128 v[76:79], v13 offset:26880
    v_mfma_f32_16x16x32_bf16 v[100:103], a[84:87], v[80:83], v[100:103]
    s_waitcnt vmcnt(7)
    s_barrier
    v_mfma_f32_16x16x32_bf16 v[104:107], a[80:83], v[84:87], v[104:107]
    ds_read_b128 v[80:83], v14 offset:0
    v_mfma_f32_16x16x32_bf16 v[108:111], a[84:87], v[84:87], v[108:111]
    buffer_load_dwordx4 v233, s[28:31], s62 offen offset:1024 sc1 lds
    v_mfma_f32_16x16x32_bf16 v[96:99], a[88:91], v[88:91], v[96:99]
    ds_read_b128 v[84:87], v14 offset:256
    v_mfma_f32_16x16x32_bf16 v[100:103], a[92:95], v[88:91], v[100:103]
    v_mfma_f32_16x16x32_bf16 v[104:107], a[88:91], v[92:95], v[104:107]
    ds_read_b128 v[88:91], v14 offset:2048
    v_mfma_f32_16x16x32_bf16 v[108:111], a[92:95], v[92:95], v[108:111]
L_pad2:
    s_cbranch_execz L_pad6
    buffer_load_dwordx4 v233, s[28:31], s62 offen offset:2048 sc1 lds
    s_waitcnt lgkmcnt(3)
    v_mfma_f32_16x16x32_bf16 v[96:99], a[96:99], v[64:67], v[96:99]
    ds_read_b128 v[92:95], v14 offset:2304
    v_mfma_f32_16x16x32_bf16 v[100:103], a[100:103], v[64:67], v[100:103]
    s_add_u32 m0, s15, 57344
    v_mfma_f32_16x16x32_bf16 v[104:107], a[96:99], v[68:71], v[104:107]
    ds_read_b128 v[64:67], v14 offset:4096
    v_mfma_f32_16x16x32_bf16 v[108:111], a[100:103], v[68:71], v[108:111]
    buffer_load_dwordx4 v232, s[28:31], s63 offen offset:0 sc1 lds
    v_mfma_f32_16x16x32_bf16 v[96:99], a[104:107], v[72:75], v[96:99]
    ds_read_b128 v[68:71], v14 offset:4352
    v_mfma_f32_16x16x32_bf16 v[100:103], a[108:111], v[72:75], v[100:103]
    v_mfma_f32_16x16x32_bf16 v[104:107], a[104:107], v[76:79], v[104:107]
    ds_read_b128 v[72:75], v14 offset:6144
    v_mfma_f32_16x16x32_bf16 v[108:111], a[108:111], v[76:79], v[108:111]
    buffer_load_dwordx4 v232, s[28:31], s63 offen offset:1024 sc1 lds
    s_waitcnt lgkmcnt(3)
    v_mfma_f32_16x16x32_bf16 v[112:115], a[0:3], v[80:83], 0
    ds_read_b128 v[76:79], v14 offset:6400
    s_lshl2_add_u32 s59, s60, s18
    v_mfma_f32_16x16x32_bf16 v[116:119], a[4:7], v[80:83], 0
    v_add_u32 v13, 28672, v251
    v_mfma_f32_16x16x32_bf16 v[120:123], a[0:3], v[84:87], 0
    ds_read_b128 v[80:83], v14 offset:8192
    v_mfma_f32_16x16x32_bf16 v[124:127], a[4:7], v[84:87], 0
    buffer_load_dwordx4 v232, s[28:31], s63 offen offset:2048 sc1 lds
    v_mfma_f32_16x16x32_bf16 v[112:115], a[8:11], v[88:91], v[112:115]
    ds_read_b128 v[84:87], v14 offset:8448
    v_fmaak_f32 v224, v96, v96, 0x409d30fc
    v_fmaak_f32 v225, v97, v97, 0x409d30fc
    v_mfma_f32_16x16x32_bf16 v[116:119], a[12:15], v[88:91], v[116:119]
    v_fmaak_f32 v226, v98, v98, 0x409d30fc
    v_fmaak_f32 v227, v99, v99, 0x409d30fc
    v_mul_f32 v224, v224, v96
    v_mfma_f32_16x16x32_bf16 v[120:123], a[8:11], v[92:95], v[120:123]
    ds_read_b128 v[88:91], v14 offset:10240
    v_mul_f32 v225, v225, v97
    v_mul_f32 v226, v226, v98
    v_mfma_f32_16x16x32_bf16 v[124:127], a[12:15], v[92:95], v[124:127]
    buffer_load_dwordx4 v232, s[28:31], s63 offen offset:3072 sc1 lds
    v_mul_f32 v227, v227, v99
    s_waitcnt lgkmcnt(3)
    v_mfma_f32_16x16x32_bf16 v[112:115], a[16:19], v[64:67], v[112:115]
    ds_read_b128 v[92:95], v14 offset:10496
    v_exp_f32 v224, -v224
    v_mfma_f32_16x16x32_bf16 v[116:119], a[20:23], v[64:67], v[116:119]
    s_add_u32 m0, s15, 61440
    v_mul_f32 v96, v96, v100
    v_mfma_f32_16x16x32_bf16 v[120:123], a[16:19], v[68:71], v[120:123]
    ds_read_b128 v[64:67], v14 offset:12288
    v_exp_f32 v225, -v225
    v_mfma_f32_16x16x32_bf16 v[124:127], a[20:23], v[68:71], v[124:127]
    buffer_load_dwordx4 v233, s[28:31], s63 offen offset:0 sc1 lds
    v_mul_f32 v97, v97, v101
    v_mfma_f32_16x16x32_bf16 v[112:115], a[24:27], v[72:75], v[112:115]
    ds_read_b128 v[68:71], v14 offset:12544
    v_exp_f32 v226, -v226
    v_mfma_f32_16x16x32_bf16 v[116:119], a[28:31], v[72:75], v[116:119]
    v_mul_f32 v98, v98, v102
    v_exp_f32 v227, -v227
    v_mfma_f32_16x16x32_bf16 v[120:123], a[24:27], v[76:79], v[120:123]
    ds_read_b128 v[72:75], v14 offset:14336
    v_mul_f32 v99, v99, v103
    v_mfma_f32_16x16x32_bf16 v[124:127], a[28:31], v[76:79], v[124:127]
    buffer_load_dwordx4 v233, s[28:31], s63 offen offset:1024 sc1 lds
    v_fma_f32 v224, v224, v250, v250
    s_waitcnt lgkmcnt(3)
    v_mfma_f32_16x16x32_bf16 v[112:115], a[32:35], v[80:83], v[112:115]
    ds_read_b128 v[76:79], v14 offset:14592
    v_fma_f32 v225, v225, v250, v250
    v_mfma_f32_16x16x32_bf16 v[116:119], a[36:39], v[80:83], v[116:119]
    v_fma_f32 v226, v226, v250, v250
    v_fma_f32 v227, v227, v250, v250
    v_rcp_f32 v224, v224
    v_mfma_f32_16x16x32_bf16 v[120:123], a[32:35], v[84:87], v[120:123]
    ds_read_b128 v[80:83], v14 offset:16384
    v_rcp_f32 v225, v225
    v_mfma_f32_16x16x32_bf16 v[124:127], a[36:39], v[84:87], v[124:127]
    buffer_load_dwordx4 v233, s[28:31], s63 offen offset:2048 sc1 lds
    v_mfma_f32_16x16x32_bf16 v[112:115], a[40:43], v[88:91], v[112:115]
    ds_read_b128 v[84:87], v14 offset:16640
    v_rcp_f32 v226, v226
    v_mfma_f32_16x16x32_bf16 v[116:119], a[44:47], v[88:91], v[116:119]
    v_rcp_f32 v227, v227
    v_mul_f32 v224, v224, v96
    v_mfma_f32_16x16x32_bf16 v[120:123], a[40:43], v[92:95], v[120:123]
    ds_read_b128 v[88:91], v14 offset:18432
    v_mul_f32 v225, v225, v97
    v_mul_f32 v226, v226, v98
    v_mfma_f32_16x16x32_bf16 v[124:127], a[44:47], v[92:95], v[124:127]
    s_add_u32 m0, s67, 147456
    s_add_u32 s7, s48, 114688
    buffer_load_dwordx4 v240, s[36:39], s7 offen offset:0 lds
    s_waitcnt lgkmcnt(3)
    v_mfma_f32_16x16x32_bf16 v[112:115], a[48:51], v[64:67], v[112:115]
    ds_read_b128 v[92:95], v14 offset:18688
    v_mfma_f32_16x16x32_bf16 v[116:119], a[52:55], v[64:67], v[116:119]
    v_mul_f32 v227, v227, v99
    v_cvt_pk_bf16_f32 v8, v224, v225
    v_mfma_f32_16x16x32_bf16 v[120:123], a[48:51], v[68:71], v[120:123]
    ds_read_b128 v[64:67], v14 offset:20480
    v_cvt_pk_bf16_f32 v9, v226, v227
    v_and_or_b32 v8, v8, v236, v249
    v_mfma_f32_16x16x32_bf16 v[124:127], a[52:55], v[68:71], v[124:127]
    buffer_load_dwordx4 v241, s[36:39], s7 offen offset:1024 lds
    v_and_b32 v9, v236, v9
    v_mfma_f32_16x16x32_bf16 v[112:115], a[56:59], v[72:75], v[112:115]
    ds_read_b128 v[68:71], v14 offset:20736
    v_fmaak_f32 v228, v104, v104, 0x409d30fc
    v_fmaak_f32 v229, v105, v105, 0x409d30fc
    v_mfma_f32_16x16x32_bf16 v[116:119], a[60:63], v[72:75], v[116:119]
    v_fmaak_f32 v230, v106, v106, 0x409d30fc
    v_fmaak_f32 v231, v107, v107, 0x409d30fc
    v_mul_f32 v228, v228, v104
    v_mfma_f32_16x16x32_bf16 v[120:123], a[56:59], v[76:79], v[120:123]
    ds_read_b128 v[72:75], v14 offset:22528
    v_mul_f32 v229, v229, v105
    v_mul_f32 v230, v230, v106
    v_mfma_f32_16x16x32_bf16 v[124:127], a[60:63], v[76:79], v[124:127]
    buffer_load_dwordx4 v242, s[36:39], s7 offen offset:2048 lds
    s_waitcnt lgkmcnt(3)
    v_mfma_f32_16x16x32_bf16 v[112:115], a[64:67], v[80:83], v[112:115]
    ds_read_b128 v[76:79], v14 offset:22784
    v_mul_f32 v231, v231, v107
    v_mfma_f32_16x16x32_bf16 v[116:119], a[68:71], v[80:83], v[116:119]
    v_exp_f32 v228, -v228
    v_mul_f32 v104, v104, v108
    v_mfma_f32_16x16x32_bf16 v[120:123], a[64:67], v[84:87], v[120:123]
    ds_read_b128 v[80:83], v14 offset:24576
    v_exp_f32 v229, -v229
    v_mfma_f32_16x16x32_bf16 v[124:127], a[68:71], v[84:87], v[124:127]
    buffer_load_dwordx4 v243, s[36:39], s7 offen offset:3072 lds
    v_mul_f32 v105, v105, v109
    v_mfma_f32_16x16x32_bf16 v[112:115], a[72:75], v[88:91], v[112:115]
    ds_read_b128 v[84:87], v14 offset:24832
    v_exp_f32 v230, -v230
    v_mfma_f32_16x16x32_bf16 v[116:119], a[76:79], v[88:91], v[116:119]
    s_add_u32 m0, s15, 86016
    v_mul_f32 v106, v106, v110
    v_exp_f32 v231, -v231
    v_mfma_f32_16x16x32_bf16 v[120:123], a[72:75], v[92:95], v[120:123]
    ds_read_b128 v[88:91], v14 offset:26624
    v_mul_f32 v107, v107, v111
    v_mfma_f32_16x16x32_bf16 v[124:127], a[76:79], v[92:95], v[124:127]
    buffer_load_dwordx4 v232, s[28:31], s64 offen offset:0 sc1 lds
    v_fma_f32 v228, v228, v250, v250
    s_waitcnt lgkmcnt(3)
    v_mfma_f32_16x16x32_bf16 v[112:115], a[80:83], v[64:67], v[112:115]
    ds_read_b128 v[92:95], v14 offset:26880
    v_mfma_f32_16x16x32_bf16 v[116:119], a[84:87], v[64:67], v[116:119]
    s_waitcnt vmcnt(12)
    s_barrier
    v_fma_f32 v229, v229, v250, v250
    v_mfma_f32_16x16x32_bf16 v[120:123], a[80:83], v[68:71], v[120:123]
    ds_read_b128 v[64:67], v13 offset:0
    v_fma_f32 v230, v230, v250, v250
    v_fma_f32 v231, v231, v250, v250
    v_mfma_f32_16x16x32_bf16 v[124:127], a[84:87], v[68:71], v[124:127]
    buffer_load_dwordx4 v232, s[28:31], s64 offen offset:1024 sc1 lds
    v_rcp_f32 v228, v228
    v_mfma_f32_16x16x32_bf16 v[112:115], a[88:91], v[72:75], v[112:115]
    ds_read_b128 v[68:71], v13 offset:256
    v_rcp_f32 v229, v229
    v_mfma_f32_16x16x32_bf16 v[116:119], a[92:95], v[72:75], v[116:119]
    s_cmp_lg_u32 s20, 0
    s_cbranch_scc1 L_nof2
    s_mov_b32 exec_hi, 0
    buffer_store_dword v238, v237, s[28:31], s45 offen sc1
    s_mov_b64 exec, -1
L_nof2:
    v_rcp_f32 v230, v230
    v_mfma_f32_16x16x32_bf16 v[120:123], a[88:91], v[76:79], v[120:123]
    ds_read_b128 v[72:75], v13 offset:2048
    v_rcp_f32 v231, v231
    v_mfma_f32_16x16x32_bf16 v[124:127], a[92:95], v[76:79], v[124:127]
    buffer_load_dwordx4 v232, s[28:31], s64 offen offset:2048 sc1 lds
    s_waitcnt lgkmcnt(3)
    v_mfma_f32_16x16x32_bf16 v[112:115], a[96:99], v[80:83], v[112:115]
    ds_read_b128 v[76:79], v13 offset:2304
    v_mul_f32 v228, v228, v104
    v_mfma_f32_16x16x32_bf16 v[116:119], a[100:103], v[80:83], v[116:119]
    v_mul_f32 v229, v229, v105
    v_mul_f32 v230, v230, v106
    v_mul_f32 v231, v231, v107
    v_mfma_f32_16x16x32_bf16 v[120:123], a[96:99], v[84:87], v[120:123]
    ds_read_b128 v[80:83], v13 offset:4096
    v_cvt_pk_bf16_f32 v10, v228, v229
    v_mfma_f32_16x16x32_bf16 v[124:127], a[100:103], v[84:87], v[124:127]
    buffer_load_dwordx4 v232, s[28:31], s64 offen offset:3072 sc1 lds
    v_cvt_pk_bf16_f32 v11, v230, v231
    v_mfma_f32_16x16x32_bf16 v[112:115], a[104:107], v[88:91], v[112:115]
    ds_read_b128 v[84:87], v13 offset:4352
    v_and_or_b32 v10, v10, v236, v249
    v_and_b32 v11, v236, v11
    v_mfma_f32_16x16x32_bf16 v[116:119], a[108:111], v[88:91], v[116:119]
    s_add_u32 m0, s15, 90112
    v_mfma_f32_16x16x32_bf16 v[120:123], a[104:107], v[92:95], v[120:123]
    ds_read_b128 v[88:91], v13 offset:6144
    v_permlane16_swap_b32 v8, v10
    v_permlane16_swap_b32 v9, v11
    buffer_store_dwordx4 v[8:11], v4, s[28:31], s59 offen sc1
    v_mfma_f32_16x16x32_bf16 v[124:127], a[108:111], v[92:95], v[124:127]
    buffer_load_dwordx4 v233, s[28:31], s64 offen offset:0 sc1 lds
    s_waitcnt lgkmcnt(3)
    v_mfma_f32_16x16x32_bf16 v[96:99], a[0:3], v[64:67], 0
    ds_read_b128 v[92:95], v13 offset:6400
    s_lshl2_add_u32 s59, s61, s18
    v_add_u32 v14, 57344, v251
    v_mfma_f32_16x16x32_bf16 v[100:103], a[4:7], v[64:67], 0
    v_mfma_f32_16x16x32_bf16 v[104:107], a[0:3], v[68:71], 0
    ds_read_b128 v[64:67], v13 offset:8192
    v_mfma_f32_16x16x32_bf16 v[108:111], a[4:7], v[68:71], 0
    buffer_load_dwordx4 v233, s[28:31], s64 offen offset:1024 sc1 lds
    v_mfma_f32_16x16x32_bf16 v[96:99], a[8:11], v[72:75], v[96:99]
    ds_read_b128 v[68:71], v13 offset:8448
    v_fmaak_f32 v224, v112, v112, 0x409d30fc
    v_fmaak_f32 v225, v113, v113, 0x409d30fc
    v_fmaak_f32 v226, v114, v114, 0x409d30fc
    v_mfma_f32_16x16x32_bf16 v[100:103], a[12:15], v[72:75], v[100:103]
    v_fmaak_f32 v227, v115, v115, 0x409d30fc
    v_mul_f32 v224, v224, v112
    v_mul_f32 v225, v225, v113
    v_mfma_f32_16x16x32_bf16 v[104:107], a[8:11], v[76:79], v[104:107]
    ds_read_b128 v[72:75], v13 offset:10240
    v_mul_f32 v226, v226, v114
    v_mul_f32 v227, v227, v115
    v_mfma_f32_16x16x32_bf16 v[108:111], a[12:15], v[76:79], v[108:111]
    buffer_load_dwordx4 v233, s[28:31], s64 offen offset:2048 sc1 lds
    v_exp_f32 v224, -v224
    s_waitcnt lgkmcnt(3)
    v_mfma_f32_16x16x32_bf16 v[96:99], a[16:19], v[80:83], v[96:99]
    ds_read_b128 v[76:79], v13 offset:10496
    v_mfma_f32_16x16x32_bf16 v[100:103], a[20:23], v[80:83], v[100:103]
    v_mul_f32 v112, v112, v116
    v_exp_f32 v225, -v225
    v_mfma_f32_16x16x32_bf16 v[104:107], a[16:19], v[84:87], v[104:107]
    ds_read_b128 v[80:83], v13 offset:12288
    v_mul_f32 v113, v113, v117
    v_exp_f32 v226, -v226
    v_mfma_f32_16x16x32_bf16 v[108:111], a[20:23], v[84:87], v[108:111]
    s_add_u32 m0, s67, 114688
    s_add_u32 s7, s54, 114688
    buffer_load_dwordx4 v240, s[36:39], s7 offen offset:0 lds
    v_mfma_f32_16x16x32_bf16 v[96:99], a[24:27], v[88:91], v[96:99]
    ds_read_b128 v[84:87], v13 offset:12544
    v_mfma_f32_16x16x32_bf16 v[100:103], a[28:31], v[88:91], v[100:103]
    v_mul_f32 v114, v114, v118
    v_exp_f32 v227, -v227
    v_mfma_f32_16x16x32_bf16 v[104:107], a[24:27], v[92:95], v[104:107]
    ds_read_b128 v[88:91], v13 offset:14336
    v_mul_f32 v115, v115, v119
    v_fma_f32 v224, v224, v250, v250
    v_mfma_f32_16x16x32_bf16 v[108:111], a[28:31], v[92:95], v[108:111]
    buffer_load_dwordx4 v241, s[36:39], s7 offen offset:1024 lds
    v_fma_f32 v225, v225, v250, v250
    s_waitcnt lgkmcnt(3)
    v_mfma_f32_16x16x32_bf16 v[96:99], a[32:35], v[64:67], v[96:99]
    ds_read_b128 v[92:95], v13 offset:14592
    v_fma_f32 v226, v226, v250, v250
    v_mfma_f32_16x16x32_bf16 v[100:103], a[36:39], v[64:67], v[100:103]
    v_fma_f32 v227, v227, v250, v250
    v_rcp_f32 v224, v224
    v_mfma_f32_16x16x32_bf16 v[104:107], a[32:35], v[68:71], v[104:107]
    ds_read_b128 v[64:67], v13 offset:16384
    v_rcp_f32 v225, v225
    v_rcp_f32 v226, v226
    v_mfma_f32_16x16x32_bf16 v[108:111], a[36:39], v[68:71], v[108:111]
    buffer_load_dwordx4 v242, s[36:39], s7 offen offset:2048 lds
    v_mfma_f32_16x16x32_bf16 v[96:99], a[40:43], v[72:75], v[96:99]
    ds_read_b128 v[68:71], v13 offset:16640
    v_rcp_f32 v227, v227
    v_mfma_f32_16x16x32_bf16 v[100:103], a[44:47], v[72:75], v[100:103]
    v_mul_f32 v224, v224, v112
    v_mul_f32 v225, v225, v113
    v_mul_f32 v226, v226, v114
    v_mfma_f32_16x16x32_bf16 v[104:107], a[40:43], v[76:79], v[104:107]
    ds_read_b128 v[72:75], v13 offset:18432
    v_mul_f32 v227, v227, v115
    v_cvt_pk_bf16_f32 v8, v224, v225
    v_mfma_f32_16x16x32_bf16 v[108:111], a[44:47], v[76:79], v[108:111]
    buffer_load_dwordx4 v243, s[36:39], s7 offen offset:3072 lds
    v_cvt_pk_bf16_f32 v9, v226, v227
    s_waitcnt lgkmcnt(3)
    v_mfma_f32_16x16x32_bf16 v[96:99], a[48:51], v[80:83], v[96:99]
    ds_read_b128 v[76:79], v13 offset:18688
    v_and_or_b32 v8, v8, v236, v249
    v_mfma_f32_16x16x32_bf16 v[100:103], a[52:55], v[80:83], v[100:103]
    s_waitcnt vmcnt(12)
    v_and_b32 v9, v236, v9
    v_fmaak_f32 v228, v120, v120, 0x409d30fc
    v_mfma_f32_16x16x32_bf16 v[104:107], a[48:51], v[84:87], v[104:107]
    ds_read_b128 v[80:83], v13 offset:20480
    ds_read_b64_tr_b16 a[160:161], v28 offset:16384
    v_fmaak_f32 v229, v121, v121, 0x409d30fc
    v_mfma_f32_16x16x32_bf16 v[108:111], a[52:55], v[84:87], v[108:111]
    s_add_u32 m0, s67, 131072
    s_add_u32 s7, s48, 0
    buffer_load_dwordx4 v240, s[36:39], s7 offen offset:0 lds
    v_mfma_f32_16x16x32_bf16 v[96:99], a[56:59], v[88:91], v[96:99]
    ds_read_b128 v[84:87], v13 offset:20736
    ds_read_b64_tr_b16 a[162:163], v28 offset:16896
    v_mfma_f32_16x16x32_bf16 v[100:103], a[60:63], v[88:91], v[100:103]
    v_fmaak_f32 v230, v122, v122, 0x409d30fc
    v_fmaak_f32 v231, v123, v123, 0x409d30fc
    v_mul_f32 v228, v228, v120
    v_mfma_f32_16x16x32_bf16 v[104:107], a[56:59], v[92:95], v[104:107]
    ds_read_b128 v[88:91], v13 offset:22528
    ds_read_b64_tr_b16 a[164:165], v29 offset:16384
    v_mul_f32 v229, v229, v121
    v_mfma_f32_16x16x32_bf16 v[108:111], a[60:63], v[92:95], v[108:111]
    buffer_load_dwordx4 v241, s[36:39], s7 offen offset:1024 lds
    v_mul_f32 v230, v230, v122
    s_waitcnt lgkmcnt(6)
    v_mfma_f32_16x16x32_bf16 v[96:99], a[64:67], v[64:67], v[96:99]
    ds_read_b128 v[92:95], v13 offset:22784
    ds_read_b64_tr_b16 a[166:167], v29 offset:16896
    v_mfma_f32_16x16x32_bf16 v[100:103], a[68:71], v[64:67], v[100:103]
    v_mul_f32 v231, v231, v123
    v_exp_f32 v228, -v228
    v_mfma_f32_16x16x32_bf16 v[104:107], a[64:67], v[68:71], v[104:107]
    ds_read_b128 v[64:67], v13 offset:24576
    ds_read_b64_tr_b16 a[168:169], v30 offset:16384
    v_mul_f32 v120, v120, v124
    v_exp_f32 v229, -v229
    v_mfma_f32_16x16x32_bf16 v[108:111], a[68:71], v[68:71], v[108:111]
    buffer_load_dwordx4 v242, s[36:39], s7 offen offset:2048 lds
    v_mfma_f32_16x16x32_bf16 v[96:99], a[72:75], v[72:75], v[96:99]
    ds_read_b128 v[68:71], v13 offset:24832
    ds_read_b64_tr_b16 a[170:171], v30 offset:16896
    v_mul_f32 v121, v121, v125
    v_mfma_f32_16x16x32_bf16 v[100:103], a[76:79], v[72:75], v[100:103]
    v_exp_f32 v230, -v230
    v_mul_f32 v122, v122, v126
    v_mfma_f32_16x16x32_bf16 v[104:107], a[72:75], v[76:79], v[104:107]
    ds_read_b128 v[72:75], v13 offset:26624
    ds_read_b64_tr_b16 a[172:173], v31 offset:16384
    v_exp_f32 v231, -v231
    v_mfma_f32_16x16x32_bf16 v[108:111], a[76:79], v[76:79], v[108:111]
    buffer_load_dwordx4 v243, s[36:39], s7 offen offset:3072 lds
    s_waitcnt lgkmcnt(7)
    v_mfma_f32_16x16x32_bf16 v[96:99], a[80:83], v[80:83], v[96:99]
    ds_read_b128 v[76:79], v13 offset:26880
    ds_read_b64_tr_b16 a[174:175], v31 offset:16896
    v_mfma_f32_16x16x32_bf16 v[100:103], a[84:87], v[80:83], v[100:103]
    s_barrier
    v_mul_f32 v123, v123, v127
    v_mfma_f32_16x16x32_bf16 v[104:107], a[80:83], v[84:87], v[104:107]
    ds_read_b128 v[80:83], v14 offset:0
    v_fma_f32 v228, v228, v250, v250
    v_fma_f32 v229, v229, v250, v250
    v_mfma_f32_16x16x32_bf16 v[108:111], a[84:87], v[84:87], v[108:111]
    s_waitcnt lgkmcnt(1)
    s_add_u32 m0, s67, 147456
    s_add_u32 s7, s50, 0
    buffer_load_dwordx4 v240, s[36:39], s7 offen offset:0 lds
    v_mfma_f32_16x16x32_bf16 v[96:99], a[88:91], v[88:91], v[96:99]
    ds_read_b128 v[84:87], v14 offset:256
    v_fma_f32 v230, v230, v250, v250
    v_mfma_f32_16x16x32_bf16 v[100:103], a[92:95], v[88:91], v[100:103]
    v_fma_f32 v231, v231, v250, v250
    v_rcp_f32 v228, v228
    v_mfma_f32_16x16x32_bf16 v[104:107], a[88:91], v[92:95], v[104:107]
    ds_read_b128 v[88:91], v14 offset:2048
    v_rcp_f32 v229, v229
    v_mfma_f32_16x16x32_bf16 v[108:111], a[92:95], v[92:95], v[108:111]
    buffer_load_dwordx4 v241, s[36:39], s7 offen offset:1024 lds
    v_rcp_f32 v230, v230
    v_mfma_f32_16x16x32_bf16 v[96:99], a[96:99], v[64:67], v[96:99]
    ds_read_b128 v[92:95], v14 offset:2304
    v_mfma_f32_16x16x32_bf16 v[100:103], a[100:103], v[64:67], v[100:103]
    v_rcp_f32 v231, v231
    v_mul_f32 v228, v228, v120
    v_mfma_f32_16x16x32_bf16 v[104:107], a[96:99], v[68:71], v[104:107]
    ds_read_b128 v[64:67], v14 offset:4096
    v_mul_f32 v229, v229, v121
    v_mul_f32 v230, v230, v122
    v_mul_f32 v231, v231, v123
    v_mfma_f32_16x16x32_bf16 v[108:111], a[100:103], v[68:71], v[108:111]
    buffer_load_dwordx4 v242, s[36:39], s7 offen offset:2048 lds
    v_mfma_f32_16x16x32_bf16 v[96:99], a[104:107], v[72:75], v[96:99]
    ds_read_b128 v[68:71], v14 offset:4352
    v_cvt_pk_bf16_f32 v10, v228, v229
    v_cvt_pk_bf16_f32 v11, v230, v231
    v_and_or_b32 v10, v10, v236, v249
    v_mfma_f32_16x16x32_bf16 v[100:103], a[108:111], v[72:75], v[100:103]
    v_and_b32 v11, v236, v11
    v_mfma_f32_16x16x32_bf16 v[104:107], a[104:107], v[76:79], v[104:107]
    ds_read_b128 v[72:75], v14 offset:6144
    v_permlane16_swap_b32 v8, v10
    v_permlane16_swap_b32 v9, v11
    buffer_store_dwordx4 v[8:11], v4, s[28:31], s59 offen sc1
    v_mfma_f32_16x16x32_bf16 v[108:111], a[108:111], v[76:79], v[108:111]
    buffer_load_dwordx4 v243, s[36:39], s7 offen offset:3072 lds
    s_waitcnt lgkmcnt(3)
    v_mfma_f32_16x16x32_bf16 v[112:115], a[0:3], v[80:83], 0
    ds_read_b128 v[76:79], v14 offset:6400
    s_lshl2_add_u32 s59, s62, s18
    v_add_u32 v13, 86016, v251
    v_mfma_f32_16x16x32_bf16 v[116:119], a[4:7], v[80:83], 0
    s_add_u32 m0, s15, 0
    v_mfma_f32_16x16x32_bf16 v[120:123], a[0:3], v[84:87], 0
    ds_read_b128 v[80:83], v14 offset:8192
    v_mfma_f32_16x16x32_bf16 v[124:127], a[4:7], v[84:87], 0
    buffer_load_dwordx4 v232, s[28:31], s65 offen offset:0 sc1 lds
    v_mfma_f32_16x16x32_bf16 v[112:115], a[8:11], v[88:91], v[112:115]
    ds_read_b128 v[84:87], v14 offset:8448
    v_fmaak_f32 v224, v96, v96, 0x409d30fc
    v_fmaak_f32 v225, v97, v97, 0x409d30fc
    v_fmaak_f32 v226, v98, v98, 0x409d30fc
    v_mfma_f32_16x16x32_bf16 v[116:119], a[12:15], v[88:91], v[116:119]
    v_fmaak_f32 v227, v99, v99, 0x409d30fc
    v_mul_f32 v224, v224, v96
    v_mul_f32 v225, v225, v97
    v_mfma_f32_16x16x32_bf16 v[120:123], a[8:11], v[92:95], v[120:123]
    ds_read_b128 v[88:91], v14 offset:10240
    v_mul_f32 v226, v226, v98
    v_mul_f32 v227, v227, v99
    v_mfma_f32_16x16x32_bf16 v[124:127], a[12:15], v[92:95], v[124:127]
    buffer_load_dwordx4 v232, s[28:31], s65 offen offset:1024 sc1 lds
    v_exp_f32 v224, -v224
    s_waitcnt lgkmcnt(3)
    v_mfma_f32_16x16x32_bf16 v[112:115], a[16:19], v[64:67], v[112:115]
    ds_read_b128 v[92:95], v14 offset:10496
    v_mul_f32 v96, v96, v100
    v_mfma_f32_16x16x32_bf16 v[116:119], a[20:23], v[64:67], v[116:119]
    s_waitcnt vmcnt(11)
    v_exp_f32 v225, -v225
    v_mfma_f32_16x16x32_bf16 v[120:123], a[16:19], v[68:71], v[120:123]
    ds_read_b128 v[64:67], v14 offset:12288
    ds_read_b64_tr_b16 a[128:129], v244 offset:57344
    v_mul_f32 v97, v97, v101
    v_mfma_f32_16x16x32_bf16 v[124:127], a[20:23], v[68:71], v[124:127]
    buffer_load_dwordx4 v232, s[28:31], s65 offen offset:2048 sc1 lds
    v_exp_f32 v226, -v226
    v_mfma_f32_16x16x32_bf16 v[112:115], a[24:27], v[72:75], v[112:115]
    ds_read_b128 v[68:71], v14 offset:12544
    ds_read_b64_tr_b16 a[130:131], v244 offset:57856
    v_mul_f32 v98, v98, v102
    v_mfma_f32_16x16x32_bf16 v[116:119], a[28:31], v[72:75], v[116:119]
    v_exp_f32 v227, -v227
    v_mul_f32 v99, v99, v103
    v_mfma_f32_16x16x32_bf16 v[120:123], a[24:27], v[76:79], v[120:123]
    ds_read_b128 v[72:75], v14 offset:14336
    ds_read_b64_tr_b16 a[132:133], v245 offset:57344
    v_fma_f32 v224, v224, v250, v250
    v_mfma_f32_16x16x32_bf16 v[124:127], a[28:31], v[76:79], v[124:127]
    buffer_load_dwordx4 v232, s[28:31], s65 offen offset:3072 sc1 lds
    v_fma_f32 v225, v225, v250, v250
    s_waitcnt lgkmcnt(6)
    v_mfma_f32_16x16x32_bf16 v[112:115], a[32:35], v[80:83], v[112:115]
    ds_read_b128 v[76:79], v14 offset:14592
    ds_read_b64_tr_b16 a[134:135], v245 offset:57856
    v_mfma_f32_16x16x32_bf16 v[116:119], a[36:39], v[80:83], v[116:119]
    s_add_u32 m0, s15, 4096
    v_fma_f32 v226, v226, v250, v250
    v_fma_f32 v227, v227, v250, v250
    v_rcp_f32 v224, v224
    v_mfma_f32_16x16x32_bf16 v[120:123], a[32:35], v[84:87], v[120:123]
    ds_read_b128 v[80:83], v14 offset:16384
    ds_read_b64_tr_b16 a[136:137], v246 offset:57344
    v_mfma_f32_16x16x32_bf16 v[124:127], a[36:39], v[84:87], v[124:127]
    buffer_load_dwordx4 v233, s[28:31], s65 offen offset:0 sc1 lds
    v_rcp_f32 v225, v225
    v_mfma_f32_16x16x32_bf16 v[112:115], a[40:43], v[88:91], v[112:115]
    ds_read_b128 v[84:87], v14 offset:16640
    ds_read_b64_tr_b16 a[138:139], v246 offset:57856
    v_mfma_f32_16x16x32_bf16 v[116:119], a[44:47], v[88:91], v[116:119]
    v_rcp_f32 v226, v226
    v_rcp_f32 v227, v227
    v_mfma_f32_16x16x32_bf16 v[120:123], a[40:43], v[92:95], v[120:123]
    ds_read_b128 v[88:91], v14 offset:18432
    ds_read_b64_tr_b16 a[140:141], v247 offset:57344
    v_mul_f32 v224, v224, v96
    v_mfma_f32_16x16x32_bf16 v[124:127], a[44:47], v[92:95], v[124:127]
    buffer_load_dwordx4 v233, s[28:31], s65 offen offset:1024 sc1 lds
    v_mul_f32 v225, v225, v97
    s_waitcnt lgkmcnt(7)
    v_mfma_f32_16x16x32_bf16 v[112:115], a[48:51], v[64:67], v[112:115]
    ds_read_b128 v[92:95], v14 offset:18688
    ds_read_b64_tr_b16 a[142:143], v247 offset:57856
    v_mfma_f32_16x16x32_bf16 v[116:119], a[52:55], v[64:67], v[116:119]
    v_mul_f32 v226, v226, v98
    v_mul_f32 v227, v227, v99
    v_cvt_pk_bf16_f32 v8, v224, v225
    v_mfma_f32_16x16x32_bf16 v[120:123], a[48:51], v[68:71], v[120:123]
    ds_read_b128 v[64:67], v14 offset:20480
    v_cvt_pk_bf16_f32 v9, v226, v227
    v_and_or_b32 v8, v8, v236, v249
    v_and_b32 v9, v236, v9
    v_mfma_f32_16x16x32_bf16 v[124:127], a[52:55], v[68:71], v[124:127]
    buffer_load_dwordx4 v233, s[28:31], s65 offen offset:2048 sc1 lds
    v_fmaak_f32 v228, v104, v104, 0x409d30fc
    v_mfma_f32_16x16x32_bf16 v[112:115], a[56:59], v[72:75], v[112:115]
    ds_read_b128 v[68:71], v14 offset:20736
    v_fmaak_f32 v229, v105, v105, 0x409d30fc
    v_fmaak_f32 v230, v106, v106, 0x409d30fc
    v_mfma_f32_16x16x32_bf16 v[116:119], a[60:63], v[72:75], v[116:119]
    s_waitcnt vmcnt(12)
    v_fmaak_f32 v231, v107, v107, 0x409d30fc
    v_mul_f32 v228, v228, v104
    v_mfma_f32_16x16x32_bf16 v[120:123], a[56:59], v[76:79], v[120:123]
    ds_read_b128 v[72:75], v14 offset:22528
    ds_read_b64_tr_b16 a[144:145], v28 offset:0
    v_mul_f32 v229, v229, v105
    v_mul_f32 v230, v230, v106
    v_mfma_f32_16x16x32_bf16 v[124:127], a[60:63], v[76:79], v[124:127]
    s_waitcnt lgkmcnt(4)
    s_add_u32 m0, s67, 114688
    s_add_u32 s7, s49, 0
    buffer_load_dwordx4 v240, s[36:39], s7 offen offset:0 lds
    v_mfma_f32_16x16x32_bf16 v[112:115], a[64:67], v[80:83], v[112:115]
    ds_read_b128 v[76:79], v14 offset:22784
    ds_read_b64_tr_b16 a[146:147], v28 offset:512
    v_mfma_f32_16x16x32_bf16 v[116:119], a[68:71], v[80:83], v[116:119]
    v_mul_f32 v231, v231, v107
    v_exp_f32 v228, -v228
    v_mfma_f32_16x16x32_bf16 v[120:123], a[64:67], v[84:87], v[120:123]
    ds_read_b128 v[80:83], v14 offset:24576
    ds_read_b64_tr_b16 a[148:149], v29 offset:0
    v_mfma_f32_16x16x32_bf16 v[124:127], a[68:71], v[84:87], v[124:127]
    buffer_load_dwordx4 v241, s[36:39], s7 offen offset:1024 lds
    v_mul_f32 v104, v104, v108
    v_mfma_f32_16x16x32_bf16 v[112:115], a[72:75], v[88:91], v[112:115]
    ds_read_b128 v[84:87], v14 offset:24832
    ds_read_b64_tr_b16 a[150:151], v29 offset:512
    v_exp_f32 v229, -v229
    v_mfma_f32_16x16x32_bf16 v[116:119], a[76:79], v[88:91], v[116:119]
    v_mul_f32 v105, v105, v109
    v_exp_f32 v230, -v230
    v_mfma_f32_16x16x32_bf16 v[120:123], a[72:75], v[92:95], v[120:123]
    ds_read_b128 v[88:91], v14 offset:26624
    ds_read_b64_tr_b16 a[152:153], v30 offset:0
    v_mul_f32 v106, v106, v110
    v_mfma_f32_16x16x32_bf16 v[124:127], a[76:79], v[92:95], v[124:127]
    buffer_load_dwordx4 v242, s[36:39], s7 offen offset:2048 lds
    v_exp_f32 v231, -v231
    s_waitcnt lgkmcnt(7)
    v_mfma_f32_16x16x32_bf16 v[112:115], a[80:83], v[64:67], v[112:115]
    ds_read_b128 v[92:95], v14 offset:26880
    ds_read_b64_tr_b16 a[154:155], v30 offset:512
    v_mfma_f32_16x16x32_bf16 v[116:119], a[84:87], v[64:67], v[116:119]
    s_barrier
    v_mul_f32 v107, v107, v111
    v_mfma_f32_16x16x32_bf16 v[120:123], a[80:83], v[68:71], v[120:123]
    ds_read_b128 v[64:67], v13 offset:0
    ds_read_b64_tr_b16 a[156:157], v31 offset:0
    v_fma_f32 v228, v228, v250, v250
    v_mfma_f32_16x16x32_bf16 v[124:127], a[84:87], v[68:71], v[124:127]
    buffer_load_dwordx4 v243, s[36:39], s7 offen offset:3072 lds
    v_fma_f32 v229, v229, v250, v250
    v_mfma_f32_16x16x32_bf16 v[112:115], a[88:91], v[72:75], v[112:115]
    ds_read_b128 v[68:71], v13 offset:256
    ds_read_b64_tr_b16 a[158:159], v31 offset:512
    v_fma_f32 v230, v230, v250, v250
    v_mfma_f32_16x16x32_bf16 v[116:119], a[92:95], v[72:75], v[116:119]
    v_fma_f32 v231, v231, v250, v250
    v_rcp_f32 v228, v228
    v_rcp_f32 v229, v229
    v_mfma_f32_16x16x32_bf16 v[120:123], a[88:91], v[76:79], v[120:123]
    ds_read_b128 v[72:75], v13 offset:2048
    v_rcp_f32 v230, v230
    v_mfma_f32_16x16x32_bf16 v[124:127], a[92:95], v[76:79], v[124:127]
    s_waitcnt lgkmcnt(1)
    s_add_u32 m0, s67, 131072
    s_add_u32 s7, s49, 114688
    buffer_load_dwordx4 v240, s[36:39], s7 offen offset:0 lds
    v_mfma_f32_16x16x32_bf16 v[112:115], a[96:99], v[80:83], v[112:115]
    ds_read_b128 v[76:79], v13 offset:2304
    v_mfma_f32_16x16x32_bf16 v[116:119], a[100:103], v[80:83], v[116:119]
    v_rcp_f32 v231, v231
    v_mul_f32 v228, v228, v104
    v_mfma_f32_16x16x32_bf16 v[120:123], a[96:99], v[84:87], v[120:123]
    ds_read_b128 v[80:83], v13 offset:4096
    v_mul_f32 v229, v229, v105
    v_mul_f32 v230, v230, v106
    v_mfma_f32_16x16x32_bf16 v[124:127], a[100:103], v[84:87], v[124:127]
    buffer_load_dwordx4 v241, s[36:39], s7 offen offset:1024 lds
    v_mul_f32 v231, v231, v107
    v_mfma_f32_16x16x32_bf16 v[112:115], a[104:107], v[88:91], v[112:115]
    ds_read_b128 v[84:87], v13 offset:4352
    v_cvt_pk_bf16_f32 v10, v228, v229
    v_cvt_pk_bf16_f32 v11, v230, v231
    v_mfma_f32_16x16x32_bf16 v[116:119], a[108:111], v[88:91], v[116:119]
    v_and_or_b32 v10, v10, v236, v249
L_pad3:
    s_cbranch_execz L_pad7
    v_and_b32 v11, v236, v11
    v_mfma_f32_16x16x32_bf16 v[120:123], a[104:107], v[92:95], v[120:123]
    ds_read_b128 v[88:91], v13 offset:6144
    v_permlane16_swap_b32 v8, v10
    v_permlane16_swap_b32 v9, v11
    buffer_store_dwordx4 v[8:11], v4, s[28:31], s59 offen sc1
    v_mfma_f32_16x16x32_bf16 v[124:127], a[108:111], v[92:95], v[124:127]
    buffer_load_dwordx4 v242, s[36:39], s7 offen offset:2048 lds
    s_waitcnt lgkmcnt(3)
    v_mfma_f32_16x16x32_bf16 v[96:99], a[0:3], v[64:67], 0
    ds_read_b128 v[92:95], v13 offset:6400
    s_lshl2_add_u32 s59, s63, s18
    v_add_u32 v14, 0, v251
    v_mfma_f32_16x16x32_bf16 v[100:103], a[4:7], v[64:67], 0
    v_mfma_f32_16x16x32_bf16 v[104:107], a[0:3], v[68:71], 0
    ds_read_b128 v[64:67], v13 offset:8192
    v_mfma_f32_16x16x32_bf16 v[108:111], a[4:7], v[68:71], 0
    buffer_load_dwordx4 v243, s[36:39], s7 offen offset:3072 lds
    v_mfma_f32_16x16x32_bf16 v[96:99], a[8:11], v[72:75], v[96:99]
    ds_read_b128 v[68:71], v13 offset:8448
    v_fmaak_f32 v224, v112, v112, 0x409d30fc
    v_fmaak_f32 v225, v113, v113, 0x409d30fc
    v_fmaak_f32 v226, v114, v114, 0x409d30fc
    v_mfma_f32_16x16x32_bf16 v[100:103], a[12:15], v[72:75], v[100:103]
    s_waitcnt vmcnt(16)
    s_add_u32 m0, s15, 28672
    v_fmaak_f32 v227, v115, v115, 0x409d30fc
    v_mfma_f32_16x16x32_bf16 v[104:107], a[8:11], v[76:79], v[104:107]
    ds_read_b128 v[72:75], v13 offset:10240
    ds_read_b64_tr_b16 a[208:209], v28 offset:16384
    v_mul_f32 v224, v224, v112
    v_mul_f32 v225, v225, v113
    v_mfma_f32_16x16x32_bf16 v[108:111], a[12:15], v[76:79], v[108:111]
    buffer_load_dwordx4 v232, s[28:31], s66 offen offset:0 sc1 lds
    v_mul_f32 v226, v226, v114
    s_waitcnt lgkmcnt(4)
    v_mfma_f32_16x16x32_bf16 v[96:99], a[16:19], v[80:83], v[96:99]
    ds_read_b128 v[76:79], v13 offset:10496
    ds_read_b64_tr_b16 a[210:211], v28 offset:16896
    v_mfma_f32_16x16x32_bf16 v[100:103], a[20:23], v[80:83], v[100:103]
    v_mul_f32 v227, v227, v115
    v_exp_f32 v224, -v224
    v_mfma_f32_16x16x32_bf16 v[104:107], a[16:19], v[84:87], v[104:107]
    ds_read_b128 v[80:83], v13 offset:12288
    ds_read_b64_tr_b16 a[212:213], v29 offset:16384
    v_mul_f32 v112, v112, v116
    v_exp_f32 v225, -v225
    v_mfma_f32_16x16x32_bf16 v[108:111], a[20:23], v[84:87], v[108:111]
    buffer_load_dwordx4 v232, s[28:31], s66 offen offset:1024 sc1 lds
    v_mfma_f32_16x16x32_bf16 v[96:99], a[24:27], v[88:91], v[96:99]
    ds_read_b128 v[84:87], v13 offset:12544
    ds_read_b64_tr_b16 a[214:215], v29 offset:16896
    v_mul_f32 v113, v113, v117
    v_mfma_f32_16x16x32_bf16 v[100:103], a[28:31], v[88:91], v[100:103]
    v_exp_f32 v226, -v226
    v_mul_f32 v114, v114, v118
    v_mfma_f32_16x16x32_bf16 v[104:107], a[24:27], v[92:95], v[104:107]
    ds_read_b128 v[88:91], v13 offset:14336
    ds_read_b64_tr_b16 a[216:217], v30 offset:16384
    v_exp_f32 v227, -v227
    v_mfma_f32_16x16x32_bf16 v[108:111], a[28:31], v[92:95], v[108:111]
    buffer_load_dwordx4 v232, s[28:31], s66 offen offset:2048 sc1 lds
    v_mul_f32 v115, v115, v119
    s_waitcnt lgkmcnt(7)
    v_mfma_f32_16x16x32_bf16 v[96:99], a[32:35], v[64:67], v[96:99]
    ds_read_b128 v[92:95], v13 offset:14592
    ds_read_b64_tr_b16 a[218:219], v30 offset:16896
    v_mfma_f32_16x16x32_bf16 v[100:103], a[36:39], v[64:67], v[100:103]
    v_fma_f32 v224, v224, v250, v250
    v_fma_f32 v225, v225, v250, v250
    v_fma_f32 v226, v226, v250, v250
    v_fma_f32 v227, v227, v250, v250
    v_mfma_f32_16x16x32_bf16 v[104:107], a[32:35], v[68:71], v[104:107]
    ds_read_b128 v[64:67], v13 offset:16384
    ds_read_b64_tr_b16 a[220:221], v31 offset:16384
    v_rcp_f32 v224, v224
    v_mfma_f32_16x16x32_bf16 v[108:111], a[36:39], v[68:71], v[108:111]
    buffer_load_dwordx4 v232, s[28:31], s66 offen offset:3072 sc1 lds
    v_mfma_f32_16x16x32_bf16 v[96:99], a[40:43], v[72:75], v[96:99]
    ds_read_b128 v[68:71], v13 offset:16640
    ds_read_b64_tr_b16 a[222:223], v31 offset:16896
    v_rcp_f32 v225, v225
    v_mfma_f32_16x16x32_bf16 v[100:103], a[44:47], v[72:75], v[100:103]
    s_add_u32 m0, s15, 32768
    v_rcp_f32 v226, v226
    v_mfma_f32_16x16x32_bf16 v[104:107], a[40:43], v[76:79], v[104:107]
    ds_read_b128 v[72:75], v13 offset:18432
    v_rcp_f32 v227, v227
    v_mfma_f32_16x16x32_bf16 v[108:111], a[44:47], v[76:79], v[108:111]
    buffer_load_dwordx4 v233, s[28:31], s66 offen offset:0 sc1 lds
    v_mul_f32 v224, v224, v112
    s_waitcnt lgkmcnt(6)
    v_mfma_f32_16x16x32_bf16 v[96:99], a[48:51], v[80:83], v[96:99]
    ds_read_b128 v[76:79], v13 offset:18688
    v_mul_f32 v225, v225, v113
    v_mfma_f32_16x16x32_bf16 v[100:103], a[52:55], v[80:83], v[100:103]
    v_mul_f32 v226, v226, v114
    v_mul_f32 v227, v227, v115
    v_cvt_pk_bf16_f32 v8, v224, v225
    v_cvt_pk_bf16_f32 v9, v226, v227
    v_mfma_f32_16x16x32_bf16 v[104:107], a[48:51], v[84:87], v[104:107]
    ds_read_b128 v[80:83], v13 offset:20480
    v_and_or_b32 v8, v8, v236, v249
    v_and_b32 v9, v236, v9
    v_mfma_f32_16x16x32_bf16 v[108:111], a[52:55], v[84:87], v[108:111]
    buffer_load_dwordx4 v233, s[28:31], s66 offen offset:1024 sc1 lds
    v_fmaak_f32 v228, v120, v120, 0x409d30fc
    v_mfma_f32_16x16x32_bf16 v[96:99], a[56:59], v[88:91], v[96:99]
    ds_read_b128 v[84:87], v13 offset:20736
    v_fmaak_f32 v229, v121, v121, 0x409d30fc
    v_fmaak_f32 v230, v122, v122, 0x409d30fc
    v_fmaak_f32 v231, v123, v123, 0x409d30fc
    v_mfma_f32_16x16x32_bf16 v[100:103], a[60:63], v[88:91], v[100:103]
    v_mul_f32 v228, v228, v120
    v_mul_f32 v229, v229, v121
    v_mul_f32 v230, v230, v122
    v_mfma_f32_16x16x32_bf16 v[104:107], a[56:59], v[92:95], v[104:107]
    ds_read_b128 v[88:91], v13 offset:22528
    v_mul_f32 v231, v231, v123
    v_exp_f32 v228, -v228
    v_mfma_f32_16x16x32_bf16 v[108:111], a[60:63], v[92:95], v[108:111]
    buffer_load_dwordx4 v233, s[28:31], s66 offen offset:2048 sc1 lds
    s_waitcnt lgkmcnt(3)
    v_mfma_f32_16x16x32_bf16 v[96:99], a[64:67], v[64:67], v[96:99]
    ds_read_b128 v[92:95], v13 offset:22784
    v_mul_f32 v120, v120, v124
    v_exp_f32 v229, -v229
    v_mfma_f32_16x16x32_bf16 v[100:103], a[68:71], v[64:67], v[100:103]
    s_waitcnt vmcnt(12)
    v_mul_f32 v121, v121, v125
    v_mfma_f32_16x16x32_bf16 v[104:107], a[64:67], v[68:71], v[104:107]
    ds_read_b128 v[64:67], v13 offset:24576
    ds_read_b64_tr_b16 a[176:177], v244 offset:57344
    v_exp_f32 v230, -v230
    v_mfma_f32_16x16x32_bf16 v[108:111], a[68:71], v[68:71], v[108:111]
    s_add_u32 m0, s67, 147456
    s_add_u32 s7, s52, 114688
    buffer_load_dwordx4 v240, s[36:39], s7 offen offset:0 lds
    v_mfma_f32_16x16x32_bf16 v[96:99], a[72:75], v[72:75], v[96:99]
    ds_read_b128 v[68:71], v13 offset:24832
    ds_read_b64_tr_b16 a[178:179], v244 offset:57856
    v_mfma_f32_16x16x32_bf16 v[100:103], a[76:79], v[72:75], v[100:103]
    v_mul_f32 v122, v122, v126
    v_exp_f32 v231, -v231
    v_mfma_f32_16x16x32_bf16 v[104:107], a[72:75], v[76:79], v[104:107]
    ds_read_b128 v[72:75], v13 offset:26624
    ds_read_b64_tr_b16 a[180:181], v245 offset:57344
    v_mul_f32 v123, v123, v127
    v_mfma_f32_16x16x32_bf16 v[108:111], a[76:79], v[76:79], v[108:111]
    buffer_load_dwordx4 v241, s[36:39], s7 offen offset:1024 lds
    v_fma_f32 v228, v228, v250, v250
    v_fma_f32 v229, v229, v250, v250
    s_waitcnt lgkmcnt(6)
    v_mfma_f32_16x16x32_bf16 v[96:99], a[80:83], v[80:83], v[96:99]
    ds_read_b128 v[76:79], v13 offset:26880
    ds_read_b64_tr_b16 a[182:183], v245 offset:57856
    v_mfma_f32_16x16x32_bf16 v[100:103], a[84:87], v[80:83], v[100:103]
    s_barrier
    v_fma_f32 v230, v230, v250, v250
    v_mfma_f32_16x16x32_bf16 v[104:107], a[80:83], v[84:87], v[104:107]
    ds_read_b128 v[80:83], v14 offset:0
    ds_read_b64_tr_b16 a[184:185], v246 offset:57344
    v_fma_f32 v231, v231, v250, v250
    v_rcp_f32 v228, v228
    v_mfma_f32_16x16x32_bf16 v[108:111], a[84:87], v[84:87], v[108:111]
    buffer_load_dwordx4 v242, s[36:39], s7 offen offset:2048 lds
    v_mfma_f32_16x16x32_bf16 v[96:99], a[88:91], v[88:91], v[96:99]
    ds_read_b128 v[84:87], v14 offset:256
    ds_read_b64_tr_b16 a[186:187], v246 offset:57856
    v_rcp_f32 v229, v229
    v_mfma_f32_16x16x32_bf16 v[100:103], a[92:95], v[88:91], v[100:103]
    v_rcp_f32 v230, v230
    v_mfma_f32_16x16x32_bf16 v[104:107], a[88:91], v[92:95], v[104:107]
    ds_read_b128 v[88:91], v14 offset:2048
    ds_read_b64_tr_b16 a[188:189], v247 offset:57344
    v_rcp_f32 v231, v231
    v_mfma_f32_16x16x32_bf16 v[108:111], a[92:95], v[92:95], v[108:111]
    buffer_load_dwordx4 v243, s[36:39], s7 offen offset:3072 lds
    v_mul_f32 v228, v228, v120
    s_waitcnt lgkmcnt(7)
    v_mfma_f32_16x16x32_bf16 v[96:99], a[96:99], v[64:67], v[96:99]
    ds_read_b128 v[92:95], v14 offset:2304
    ds_read_b64_tr_b16 a[190:191], v247 offset:57856
    v_mfma_f32_16x16x32_bf16 v[100:103], a[100:103], v[64:67], v[100:103]
    v_mul_f32 v229, v229, v121
    v_mul_f32 v230, v230, v122
    v_mul_f32 v231, v231, v123
    v_mfma_f32_16x16x32_bf16 v[104:107], a[96:99], v[68:71], v[104:107]
    ds_read_b128 v[64:67], v14 offset:4096
    v_cvt_pk_bf16_f32 v10, v228, v229
    v_cvt_pk_bf16_f32 v11, v230, v231
    v_and_or_b32 v10, v10, v236, v249
    v_mfma_f32_16x16x32_bf16 v[108:111], a[100:103], v[68:71], v[108:111]
    s_waitcnt lgkmcnt(1)
    s_add_u32 m0, s67, 114688
    s_add_u32 s7, s50, 114688
    buffer_load_dwordx4 v240, s[36:39], s7 offen offset:0 lds
    v_mfma_f32_16x16x32_bf16 v[96:99], a[104:107], v[72:75], v[96:99]
    ds_read_b128 v[68:71], v14 offset:4352
    v_and_b32 v11, v236, v11
    v_mfma_f32_16x16x32_bf16 v[100:103], a[108:111], v[72:75], v[100:103]
    buffer_load_dword v234, v239, s[28:31], s47 offen sc1
    v_mfma_f32_16x16x32_bf16 v[104:107], a[104:107], v[76:79], v[104:107]
    ds_read_b128 v[72:75], v14 offset:6144
    v_permlane16_swap_b32 v8, v10
    v_permlane16_swap_b32 v9, v11
    buffer_store_dwordx4 v[8:11], v4, s[28:31], s59 offen sc1
    v_mfma_f32_16x16x32_bf16 v[108:111], a[108:111], v[76:79], v[108:111]
    buffer_load_dwordx4 v241, s[36:39], s7 offen offset:1024 lds
    v_mfma_f32_16x16x32_bf16 v[112:115], a[0:3], v[80:83], 0
    ds_read_b128 v[76:79], v14 offset:6400
    s_lshl2_add_u32 s59, s64, s18
    v_add_u32 v13, 28672, v251
    v_mfma_f32_16x16x32_bf16 v[116:119], a[4:7], v[80:83], 0
    s_waitcnt vmcnt(15)
    v_mfma_f32_16x16x32_bf16 v[120:123], a[0:3], v[84:87], 0
    ds_read_b128 v[80:83], v14 offset:8192
    ds_read_b64_tr_b16 a[192:193], v28 offset:0
    v_mfma_f32_16x16x32_bf16 v[124:127], a[4:7], v[84:87], 0
    buffer_load_dwordx4 v242, s[36:39], s7 offen offset:2048 lds
    v_mfma_f32_16x16x32_bf16 v[112:115], a[8:11], v[88:91], v[112:115]
    ds_read_b128 v[84:87], v14 offset:8448
    ds_read_b64_tr_b16 a[194:195], v28 offset:512
    v_fmaak_f32 v224, v96, v96, 0x409d30fc
    v_fmaak_f32 v225, v97, v97, 0x409d30fc
    v_mfma_f32_16x16x32_bf16 v[116:119], a[12:15], v[88:91], v[116:119]
    v_fmaak_f32 v226, v98, v98, 0x409d30fc
    v_fmaak_f32 v227, v99, v99, 0x409d30fc
    v_mul_f32 v224, v224, v96
    v_mfma_f32_16x16x32_bf16 v[120:123], a[8:11], v[92:95], v[120:123]
    ds_read_b128 v[88:91], v14 offset:10240
    ds_read_b64_tr_b16 a[196:197], v29 offset:0
    v_mul_f32 v225, v225, v97
    v_mfma_f32_16x16x32_bf16 v[124:127], a[12:15], v[92:95], v[124:127]
    buffer_load_dwordx4 v243, s[36:39], s7 offen offset:3072 lds
    v_mul_f32 v226, v226, v98
    s_waitcnt lgkmcnt(6)
    v_mfma_f32_16x16x32_bf16 v[112:115], a[16:19], v[64:67], v[112:115]
    ds_read_b128 v[92:95], v14 offset:10496
    ds_read_b64_tr_b16 a[198:199], v29 offset:512
    v_mfma_f32_16x16x32_bf16 v[116:119], a[20:23], v[64:67], v[116:119]
    v_mul_f32 v227, v227, v99
    v_exp_f32 v224, -v224
    v_mfma_f32_16x16x32_bf16 v[120:123], a[16:19], v[68:71], v[120:123]
    ds_read_b128 v[64:67], v14 offset:12288
    ds_read_b64_tr_b16 a[200:201], v30 offset:0
    v_mul_f32 v96, v96, v100
    v_mfma_f32_16x16x32_bf16 v[124:127], a[20:23], v[68:71], v[124:127]
    s_add_u32 m0, s67, 57344
    s_add_u32 s7, s51, 114688
    buffer_load_dwordx4 v240, s[36:39], s7 offen offset:0 lds
    v_mfma_f32_16x16x32_bf16 v[112:115], a[24:27], v[72:75], v[112:115]
    ds_read_b128 v[68:71], v14 offset:12544
    ds_read_b64_tr_b16 a[202:203], v30 offset:512
    v_mfma_f32_16x16x32_bf16 v[116:119], a[28:31], v[72:75], v[116:119]
    v_exp_f32 v225, -v225
    v_mul_f32 v97, v97, v101
    v_mfma_f32_16x16x32_bf16 v[120:123], a[24:27], v[76:79], v[120:123]
    ds_read_b128 v[72:75], v14 offset:14336
    ds_read_b64_tr_b16 a[204:205], v31 offset:0
    v_exp_f32 v226, -v226
    v_mfma_f32_16x16x32_bf16 v[124:127], a[28:31], v[76:79], v[124:127]
    buffer_load_dwordx4 v241, s[36:39], s7 offen offset:1024 lds
    s_waitcnt lgkmcnt(7)
    v_mfma_f32_16x16x32_bf16 v[112:115], a[32:35], v[80:83], v[112:115]
    ds_read_b128 v[76:79], v14 offset:14592
    ds_read_b64_tr_b16 a[206:207], v31 offset:512
    v_mfma_f32_16x16x32_bf16 v[116:119], a[36:39], v[80:83], v[116:119]
    v_mul_f32 v98, v98, v102
    v_exp_f32 v227, -v227
    v_mfma_f32_16x16x32_bf16 v[120:123], a[32:35], v[84:87], v[120:123]
    ds_read_b128 v[80:83], v14 offset:16384
    v_mul_f32 v99, v99, v103
    v_fma_f32 v224, v224, v250, v250
    v_mfma_f32_16x16x32_bf16 v[124:127], a[36:39], v[84:87], v[124:127]
    buffer_load_dwordx4 v242, s[36:39], s7 offen offset:2048 lds
    v_fma_f32 v225, v225, v250, v250
    v_mfma_f32_16x16x32_bf16 v[112:115], a[40:43], v[88:91], v[112:115]
    ds_read_b128 v[84:87], v14 offset:16640
    v_fma_f32 v226, v226, v250, v250
    v_fma_f32 v227, v227, v250, v250
    v_mfma_f32_16x16x32_bf16 v[116:119], a[44:47], v[88:91], v[116:119]
    v_rcp_f32 v224, v224
    v_rcp_f32 v225, v225
    v_mfma_f32_16x16x32_bf16 v[120:123], a[40:43], v[92:95], v[120:123]
    ds_read_b128 v[88:91], v14 offset:18432
    v_rcp_f32 v226, v226
    v_mfma_f32_16x16x32_bf16 v[124:127], a[44:47], v[92:95], v[124:127]
    buffer_load_dwordx4 v243, s[36:39], s7 offen offset:3072 lds
    s_waitcnt lgkmcnt(4)
    v_mfma_f32_16x16x32_bf16 v[112:115], a[48:51], v[64:67], v[112:115]
    ds_read_b128 v[92:95], v14 offset:18688
    v_rcp_f32 v227, v227
    v_mfma_f32_16x16x32_bf16 v[116:119], a[52:55], v[64:67], v[116:119]
    v_mul_f32 v224, v224, v96
    v_mul_f32 v225, v225, v97
    v_mul_f32 v226, v226, v98
    v_mfma_f32_16x16x32_bf16 v[120:123], a[48:51], v[68:71], v[120:123]
    ds_read_b128 v[64:67], v14 offset:20480
    v_mul_f32 v227, v227, v99
    v_cvt_pk_bf16_f32 v8, v224, v225
    v_mfma_f32_16x16x32_bf16 v[124:127], a[52:55], v[68:71], v[124:127]
    s_waitcnt lgkmcnt(5)
    s_add_u32 m0, s67, 131072
    s_add_u32 s7, s51, 0
    buffer_load_dwordx4 v240, s[36:39], s7 offen offset:0 lds
    v_mfma_f32_16x16x32_bf16 v[112:115], a[56:59], v[72:75], v[112:115]
    ds_read_b128 v[68:71], v14 offset:20736
    v_cvt_pk_bf16_f32 v9, v226, v227
    v_mfma_f32_16x16x32_bf16 v[116:119], a[60:63], v[72:75], v[116:119]
    v_and_or_b32 v8, v8, v236, v249
    v_and_b32 v9, v236, v9
    v_fmaak_f32 v228, v104, v104, 0x409d30fc
    v_mfma_f32_16x16x32_bf16 v[120:123], a[56:59], v[76:79], v[120:123]
    ds_read_b128 v[72:75], v14 offset:22528
    v_fmaak_f32 v229, v105, v105, 0x409d30fc
    v_fmaak_f32 v230, v106, v106, 0x409d30fc
    v_mfma_f32_16x16x32_bf16 v[124:127], a[60:63], v[76:79], v[124:127]
    buffer_load_dwordx4 v241, s[36:39], s7 offen offset:1024 lds
    v_fmaak_f32 v231, v107, v107, 0x409d30fc
    s_waitcnt lgkmcnt(3)
    v_mfma_f32_16x16x32_bf16 v[112:115], a[64:67], v[80:83], v[112:115]
    ds_read_b128 v[76:79], v14 offset:22784
    v_mul_f32 v228, v228, v104
    v_mfma_f32_16x16x32_bf16 v[116:119], a[68:71], v[80:83], v[116:119]
    v_mul_f32 v229, v229, v105
    v_mul_f32 v230, v230, v106
    v_mul_f32 v231, v231, v107
    v_mfma_f32_16x16x32_bf16 v[120:123], a[64:67], v[84:87], v[120:123]
    ds_read_b128 v[80:83], v14 offset:24576
    v_exp_f32 v228, -v228
    v_mfma_f32_16x16x32_bf16 v[124:127], a[68:71], v[84:87], v[124:127]
    buffer_load_dwordx4 v242, s[36:39], s7 offen offset:2048 lds
    v_mul_f32 v104, v104, v108
    v_mfma_f32_16x16x32_bf16 v[112:115], a[72:75], v[88:91], v[112:115]
    ds_read_b128 v[84:87], v14 offset:24832
    v_exp_f32 v229, -v229
    v_mfma_f32_16x16x32_bf16 v[116:119], a[76:79], v[88:91], v[116:119]
    v_mul_f32 v105, v105, v109
    v_exp_f32 v230, -v230
    v_mfma_f32_16x16x32_bf16 v[120:123], a[72:75], v[92:95], v[120:123]
    ds_read_b128 v[88:91], v14 offset:26624
    v_mul_f32 v106, v106, v110
    v_exp_f32 v231, -v231
    v_mfma_f32_16x16x32_bf16 v[124:127], a[76:79], v[92:95], v[124:127]
    buffer_load_dwordx4 v243, s[36:39], s7 offen offset:3072 lds
    s_waitcnt lgkmcnt(3)
    v_mfma_f32_16x16x32_bf16 v[112:115], a[80:83], v[64:67], v[112:115]
    ds_read_b128 v[92:95], v14 offset:26880
    v_mul_f32 v107, v107, v111
    v_mfma_f32_16x16x32_bf16 v[116:119], a[84:87], v[64:67], v[116:119]
    s_waitcnt vmcnt(18)
    s_barrier
    v_fma_f32 v228, v228, v250, v250
    v_mfma_f32_16x16x32_bf16 v[120:123], a[80:83], v[68:71], v[120:123]
    ds_read_b128 v[64:67], v13 offset:0
    v_fma_f32 v229, v229, v250, v250
    v_fma_f32 v230, v230, v250, v250
    v_mfma_f32_16x16x32_bf16 v[124:127], a[84:87], v[68:71], v[124:127]
    buffer_load_dwordx4 v[128:131], v24, s[28:31], s8 offen offset:0 sc1
    v_fma_f32 v231, v231, v250, v250
    v_mfma_f32_16x16x32_bf16 v[112:115], a[88:91], v[72:75], v[112:115]
    ds_read_b128 v[68:71], v13 offset:256
    v_rcp_f32 v228, v228
    v_mfma_f32_16x16x32_bf16 v[116:119], a[92:95], v[72:75], v[116:119]
    s_waitcnt vmcnt(13)
    v_cmp_ne_u32 vcc, s56, v234
    v_rcp_f32 v229, v229
    v_mfma_f32_16x16x32_bf16 v[120:123], a[88:91], v[76:79], v[120:123]
    ds_read_b128 v[72:75], v13 offset:2048
    v_rcp_f32 v230, v230
    v_mfma_f32_16x16x32_bf16 v[124:127], a[92:95], v[76:79], v[124:127]
    s_cbranch_vccnz L_f2
L_f2_ret:
    buffer_load_dwordx4 v[132:135], v24, s[28:31], s8 offen offset:256 sc1
    s_waitcnt lgkmcnt(3)
    v_mfma_f32_16x16x32_bf16 v[112:115], a[96:99], v[80:83], v[112:115]
    ds_read_b128 v[76:79], v13 offset:2304
    v_rcp_f32 v231, v231
    v_mfma_f32_16x16x32_bf16 v[116:119], a[100:103], v[80:83], v[116:119]
    v_mul_f32 v228, v228, v104
    v_mul_f32 v229, v229, v105
    v_mfma_f32_16x16x32_bf16 v[120:123], a[96:99], v[84:87], v[120:123]
    ds_read_b128 v[80:83], v13 offset:4096
    v_mul_f32 v230, v230, v106
    v_mul_f32 v231, v231, v107
    v_mfma_f32_16x16x32_bf16 v[124:127], a[100:103], v[84:87], v[124:127]
    buffer_load_dwordx4 v[136:139], v25, s[28:31], s8 offen offset:0 sc1
    v_cvt_pk_bf16_f32 v10, v228, v229
    v_mfma_f32_16x16x32_bf16 v[112:115], a[104:107], v[88:91], v[112:115]
    ds_read_b128 v[84:87], v13 offset:4352
    v_cvt_pk_bf16_f32 v11, v230, v231
    v_and_or_b32 v10, v10, v236, v249
    v_mfma_f32_16x16x32_bf16 v[116:119], a[108:111], v[88:91], v[116:119]
    v_and_b32 v11, v236, v11
    v_mfma_f32_16x16x32_bf16 v[120:123], a[104:107], v[92:95], v[120:123]
    ds_read_b128 v[88:91], v13 offset:6144
    v_permlane16_swap_b32 v8, v10
    v_permlane16_swap_b32 v9, v11
    buffer_store_dwordx4 v[8:11], v4, s[28:31], s59 offen sc1
    v_mfma_f32_16x16x32_bf16 v[124:127], a[108:111], v[92:95], v[124:127]
    buffer_load_dwordx4 v[140:143], v25, s[28:31], s8 offen offset:256 sc1
    s_waitcnt lgkmcnt(3)
    v_mfma_f32_16x16x32_bf16 v[96:99], a[0:3], v[64:67], 0
    ds_read_b128 v[92:95], v13 offset:6400
    s_lshl2_add_u32 s59, s65, s18
    v_mfma_f32_16x16x32_bf16 v[100:103], a[4:7], v[64:67], 0
    s_waitcnt vmcnt(13)
    v_mfma_f32_16x16x32_bf16 v[104:107], a[0:3], v[68:71], 0
    ds_read_b128 v[64:67], v13 offset:8192
    ds_read_b64_tr_b16 a[224:225], v244 offset:57344
    v_mfma_f32_16x16x32_bf16 v[108:111], a[4:7], v[68:71], 0
    buffer_load_dwordx4 v[144:147], v26, s[28:31], s14 offen offset:0 sc1
    v_mfma_f32_16x16x32_bf16 v[96:99], a[8:11], v[72:75], v[96:99]
    ds_read_b128 v[68:71], v13 offset:8448
    ds_read_b64_tr_b16 a[226:227], v244 offset:57856
    v_fmaak_f32 v224, v112, v112, 0x409d30fc
    v_fmaak_f32 v225, v113, v113, 0x409d30fc
    v_mfma_f32_16x16x32_bf16 v[100:103], a[12:15], v[72:75], v[100:103]
    v_fmaak_f32 v226, v114, v114, 0x409d30fc
    v_fmaak_f32 v227, v115, v115, 0x409d30fc
    v_mul_f32 v224, v224, v112
    v_mfma_f32_16x16x32_bf16 v[104:107], a[8:11], v[76:79], v[104:107]
    ds_read_b128 v[72:75], v13 offset:10240
    ds_read_b64_tr_b16 a[228:229], v245 offset:57344
    v_mul_f32 v225, v225, v113
    v_mul_f32 v226, v226, v114
    v_mfma_f32_16x16x32_bf16 v[108:111], a[12:15], v[76:79], v[108:111]
    buffer_load_dwordx4 v[148:151], v26, s[28:31], s14 offen offset:256 sc1
    v_mul_f32 v227, v227, v115
    s_waitcnt lgkmcnt(6)
    v_mfma_f32_16x16x32_bf16 v[96:99], a[16:19], v[80:83], v[96:99]
    ds_read_b128 v[76:79], v13 offset:10496
    ds_read_b64_tr_b16 a[230:231], v245 offset:57856
    v_mfma_f32_16x16x32_bf16 v[100:103], a[20:23], v[80:83], v[100:103]
    v_exp_f32 v224, -v224
    v_mul_f32 v112, v112, v116
    v_exp_f32 v225, -v225
    v_mfma_f32_16x16x32_bf16 v[104:107], a[16:19], v[84:87], v[104:107]
    ds_read_b128 v[80:83], v13 offset:12288
    ds_read_b64_tr_b16 a[232:233], v246 offset:57344
    v_mfma_f32_16x16x32_bf16 v[108:111], a[20:23], v[84:87], v[108:111]
    buffer_load_dwordx4 v[152:155], v27, s[28:31], s14 offen offset:0 sc1
    v_mul_f32 v113, v113, v117
    v_mfma_f32_16x16x32_bf16 v[96:99], a[24:27], v[88:91], v[96:99]
    ds_read_b128 v[84:87], v13 offset:12544
    ds_read_b64_tr_b16 a[234:235], v246 offset:57856
    v_exp_f32 v226, -v226
    v_mfma_f32_16x16x32_bf16 v[100:103], a[28:31], v[88:91], v[100:103]
    v_mul_f32 v114, v114, v118
    v_exp_f32 v227, -v227
    v_mfma_f32_16x16x32_bf16 v[104:107], a[24:27], v[92:95], v[104:107]
    ds_read_b128 v[88:91], v13 offset:14336
    ds_read_b64_tr_b16 a[236:237], v247 offset:57344
    v_mul_f32 v115, v115, v119
    v_mfma_f32_16x16x32_bf16 v[108:111], a[28:31], v[92:95], v[108:111]
    buffer_load_dwordx4 v[156:159], v27, s[28:31], s14 offen offset:256 sc1
    v_fma_f32 v224, v224, v250, v250
    s_waitcnt lgkmcnt(7)
    v_mfma_f32_16x16x32_bf16 v[96:99], a[32:35], v[64:67], v[96:99]
    ds_read_b128 v[92:95], v13 offset:14592
    ds_read_b64_tr_b16 a[238:239], v247 offset:57856
    v_fma_f32 v225, v225, v250, v250
    v_mfma_f32_16x16x32_bf16 v[100:103], a[36:39], v[64:67], v[100:103]
    v_fma_f32 v226, v226, v250, v250
    v_fma_f32 v227, v227, v250, v250
    v_rcp_f32 v224, v224
    v_mfma_f32_16x16x32_bf16 v[104:107], a[32:35], v[68:71], v[104:107]
    ds_read_b128 v[64:67], v13 offset:16384
    v_rcp_f32 v225, v225
    v_mfma_f32_16x16x32_bf16 v[108:111], a[36:39], v[68:71], v[108:111]
    buffer_load_dwordx4 v[160:163], v24, s[28:31], s9 offen offset:0 sc1
    v_rcp_f32 v226, v226
    v_mfma_f32_16x16x32_bf16 v[96:99], a[40:43], v[72:75], v[96:99]
    ds_read_b128 v[68:71], v13 offset:16640
    v_rcp_f32 v227, v227
    v_mfma_f32_16x16x32_bf16 v[100:103], a[44:47], v[72:75], v[100:103]
    s_waitcnt vmcnt(10)
    v_mul_f32 v224, v224, v112
    v_mul_f32 v225, v225, v113
    v_mfma_f32_16x16x32_bf16 v[104:107], a[40:43], v[76:79], v[104:107]
    ds_read_b128 v[72:75], v13 offset:18432
    ds_read_b64_tr_b16 a[240:241], v28 offset:0
    v_mul_f32 v226, v226, v114
    v_mfma_f32_16x16x32_bf16 v[108:111], a[44:47], v[76:79], v[108:111]
    buffer_load_dwordx4 v[164:167], v24, s[28:31], s9 offen offset:256 sc1
    v_mul_f32 v227, v227, v115
    s_waitcnt lgkmcnt(5)
    v_mfma_f32_16x16x32_bf16 v[96:99], a[48:51], v[80:83], v[96:99]
    ds_read_b128 v[76:79], v13 offset:18688
    ds_read_b64_tr_b16 a[242:243], v28 offset:512
    v_cvt_pk_bf16_f32 v8, v224, v225
    v_mfma_f32_16x16x32_bf16 v[100:103], a[52:55], v[80:83], v[100:103]
    v_cvt_pk_bf16_f32 v9, v226, v227
    v_and_or_b32 v8, v8, v236, v249
    v_and_b32 v9, v236, v9
    v_mfma_f32_16x16x32_bf16 v[104:107], a[48:51], v[84:87], v[104:107]
    ds_read_b128 v[80:83], v13 offset:20480
    ds_read_b64_tr_b16 a[244:245], v29 offset:0
    v_fmaak_f32 v228, v120, v120, 0x409d30fc
    v_mfma_f32_16x16x32_bf16 v[108:111], a[52:55], v[84:87], v[108:111]
    buffer_load_dwordx4 v[168:171], v25, s[28:31], s9 offen offset:0 sc1
    v_fmaak_f32 v229, v121, v121, 0x409d30fc
    v_mfma_f32_16x16x32_bf16 v[96:99], a[56:59], v[88:91], v[96:99]
    ds_read_b128 v[84:87], v13 offset:20736
    ds_read_b64_tr_b16 a[246:247], v29 offset:512
    v_fmaak_f32 v230, v122, v122, 0x409d30fc
    v_fmaak_f32 v231, v123, v123, 0x409d30fc
    v_mfma_f32_16x16x32_bf16 v[100:103], a[60:63], v[88:91], v[100:103]
    v_mul_f32 v228, v228, v120
    v_mul_f32 v229, v229, v121
    v_mul_f32 v230, v230, v122
    v_mfma_f32_16x16x32_bf16 v[104:107], a[56:59], v[92:95], v[104:107]
    ds_read_b128 v[88:91], v13 offset:22528
    ds_read_b64_tr_b16 a[248:249], v30 offset:0
    v_mul_f32 v231, v231, v123
    v_exp_f32 v228, -v228
    v_mfma_f32_16x16x32_bf16 v[108:111], a[60:63], v[92:95], v[108:111]
    buffer_load_dwordx4 v[172:175], v25, s[28:31], s9 offen offset:256 sc1
    s_waitcnt lgkmcnt(7)
    v_mfma_f32_16x16x32_bf16 v[96:99], a[64:67], v[64:67], v[96:99]
    ds_read_b128 v[92:95], v13 offset:22784
    ds_read_b64_tr_b16 a[250:251], v30 offset:512
    v_mfma_f32_16x16x32_bf16 v[100:103], a[68:71], v[64:67], v[100:103]
    v_mul_f32 v120, v120, v124
    v_exp_f32 v229, -v229
    v_mul_f32 v121, v121, v125
    v_mfma_f32_16x16x32_bf16 v[104:107], a[64:67], v[68:71], v[104:107]
    ds_read_b128 v[64:67], v13 offset:24576
    ds_read_b64_tr_b16 a[252:253], v31 offset:0
    v_exp_f32 v230, -v230
    v_mfma_f32_16x16x32_bf16 v[108:111], a[68:71], v[68:71], v[108:111]
    buffer_load_dwordx4 v[176:179], v26, s[28:31], s8 offen offset:0 sc1
    v_mfma_f32_16x16x32_bf16 v[96:99], a[72:75], v[72:75], v[96:99]
    ds_read_b128 v[68:71], v13 offset:24832
    ds_read_b64_tr_b16 a[254:255], v31 offset:512
    v_mul_f32 v122, v122, v126
    v_exp_f32 v231, -v231
    v_mfma_f32_16x16x32_bf16 v[100:103], a[76:79], v[72:75], v[100:103]
    v_mul_f32 v123, v123, v127
    v_fma_f32 v228, v228, v250, v250
    v_mfma_f32_16x16x32_bf16 v[104:107], a[72:75], v[76:79], v[104:107]
    ds_read_b128 v[72:75], v13 offset:26624
    v_fma_f32 v229, v229, v250, v250
    v_fma_f32 v230, v230, v250, v250
    v_mfma_f32_16x16x32_bf16 v[108:111], a[76:79], v[76:79], v[108:111]
    buffer_load_dwordx4 v[180:183], v26, s[28:31], s8 offen offset:256 sc1
    v_fma_f32 v231, v231, v250, v250
    s_waitcnt lgkmcnt(6)
    v_mfma_f32_16x16x32_bf16 v[96:99], a[80:83], v[80:83], v[96:99]
    ds_read_b128 v[76:79], v13 offset:26880
    v_rcp_f32 v228, v228
    v_mfma_f32_16x16x32_bf16 v[100:103], a[84:87], v[80:83], v[100:103]
    v_rcp_f32 v229, v229
    v_rcp_f32 v230, v230
    v_mfma_f32_16x16x32_bf16 v[104:107], a[80:83], v[84:87], v[104:107]
    v_rcp_f32 v231, v231
    v_mfma_f32_16x16x32_bf16 v[108:111], a[84:87], v[84:87], v[108:111]
    buffer_load_dwordx4 v[184:187], v27, s[28:31], s8 offen offset:0 sc1
    v_mul_f32 v228, v228, v120
    v_mfma_f32_16x16x32_bf16 v[96:99], a[88:91], v[88:91], v[96:99]
    v_mul_f32 v229, v229, v121
    v_mul_f32 v230, v230, v122
    v_mfma_f32_16x16x32_bf16 v[100:103], a[92:95], v[88:91], v[100:103]
    s_waitcnt vmcnt(11)
    v_xor_b32 v128, s44, v128
    v_or3_b32 v252, v129, v130, v131
    v_xor_b32 v132, s44, v132
    v_mfma_f32_16x16x32_bf16 v[104:107], a[88:91], v[92:95], v[104:107]
    v_mul_f32 v231, v231, v123
    v_cvt_pk_bf16_f32 v10, v228, v229
    v_mfma_f32_16x16x32_bf16 v[108:111], a[92:95], v[92:95], v[108:111]
    v_or3_b32 v252, v252, v128, v133
    v_or3_b32 v252, v252, v134, v135
    buffer_load_dwordx4 v[188:191], v27, s[28:31], s8 offen offset:256 sc1
    s_waitcnt lgkmcnt(0)
    v_mfma_f32_16x16x32_bf16 v[96:99], a[96:99], v[64:67], v[96:99]
    v_mfma_f32_16x16x32_bf16 v[100:103], a[100:103], v[64:67], v[100:103]
    v_xor_b32 v136, s44, v136
    v_or3_b32 v252, v252, v132, v137
    v_or3_b32 v252, v252, v138, v139
    v_xor_b32 v140, s44, v140
    v_mfma_f32_16x16x32_bf16 v[104:107], a[96:99], v[68:71], v[104:107]
    v_cvt_pk_bf16_f32 v11, v230, v231
    v_and_or_b32 v10, v10, v236, v249
    v_mfma_f32_16x16x32_bf16 v[108:111], a[100:103], v[68:71], v[108:111]
    v_or3_b32 v252, v252, v136, v141
    v_or3_b32 v252, v252, v142, v143
L_pad4:
    s_cbranch_execz L_pad8
    buffer_load_dwordx4 v[192:195], v24, s[28:31], s10 offen offset:0 sc1
    v_mfma_f32_16x16x32_bf16 v[96:99], a[104:107], v[72:75], v[96:99]
    v_and_b32 v11, v236, v11
    v_mfma_f32_16x16x32_bf16 v[100:103], a[108:111], v[72:75], v[100:103]
    v_bitop3_b32 v252, v252, v140, v236 bitop3:0x54
    v_cmp_ne_u32 vcc, 0, v252
    v_permlane16_swap_b32 v8, v10
    v_permlane16_swap_b32 v9, v11
    v_mfma_f32_16x16x32_bf16 v[104:107], a[104:107], v[76:79], v[104:107]
    buffer_store_dwordx4 v[8:11], v4, s[28:31], s59 offen sc1
    v_mfma_f32_16x16x32_bf16 v[108:111], a[108:111], v[76:79], v[108:111]
    s_cbranch_vccnz L_ar_00
L_arr_00:
    buffer_load_dwordx4 v[196:199], v24, s[28:31], s10 offen offset:256 sc1
    v_mfma_f32_16x16x32_bf16 v[32:35], a[144:147], v[128:131], 0
    v_mfma_f32_16x16x32_bf16 v[36:39], a[148:151], v[128:131], 0
    buffer_load_dwordx4 v[200:203], v25, s[28:31], s10 offen offset:0 sc1
    v_mfma_f32_16x16x32_bf16 v[40:43], a[152:155], v[128:131], 0
    s_lshl2_add_u32 s59, s66, s18
    v_fmaak_f32 v224, v96, v96, 0x409d30fc
    v_fmaak_f32 v225, v97, v97, 0x409d30fc
    v_mfma_f32_16x16x32_bf16 v[44:47], a[156:159], v[128:131], 0
    buffer_load_dwordx4 v[204:207], v25, s[28:31], s10 offen offset:256 sc1
    v_fmaak_f32 v226, v98, v98, 0x409d30fc
    v_mfma_f32_16x16x32_bf16 v[48:51], a[144:147], v[132:135], 0
    v_fmaak_f32 v227, v99, v99, 0x409d30fc
    v_mul_f32 v224, v224, v96
    v_mul_f32 v225, v225, v97
    v_mfma_f32_16x16x32_bf16 v[52:55], a[148:151], v[132:135], 0
    buffer_load_dwordx4 v[208:211], v26, s[28:31], s9 offen offset:0 sc1
    v_mul_f32 v226, v226, v98
    v_mfma_f32_16x16x32_bf16 v[56:59], a[152:155], v[132:135], 0
    v_mul_f32 v227, v227, v99
    v_exp_f32 v224, -v224
    v_mfma_f32_16x16x32_bf16 v[60:63], a[156:159], v[132:135], 0
    s_barrier
    v_mul_f32 v96, v96, v100
    v_exp_f32 v225, -v225
    v_mfma_f32_16x16x32_bf16 v[32:35], a[160:163], v[136:139], v[32:35]
    s_waitcnt vmcnt(14)
    v_xor_b32 v144, s44, v144
    v_or3_b32 v252, v145, v146, v147
    v_mfma_f32_16x16x32_bf16 v[36:39], a[164:167], v[136:139], v[36:39]
    buffer_load_dwordx4 v[212:215], v26, s[28:31], s9 offen offset:256 sc1
    v_xor_b32 v148, s44, v148
    v_mfma_f32_16x16x32_bf16 v[40:43], a[168:171], v[136:139], v[40:43]
    v_or3_b32 v252, v252, v144, v149
    v_or3_b32 v252, v252, v150, v151
    v_xor_b32 v152, s44, v152
    v_mfma_f32_16x16x32_bf16 v[44:47], a[172:175], v[136:139], v[44:47]
    v_or3_b32 v252, v252, v148, v153
    v_or3_b32 v252, v252, v154, v155
    v_xor_b32 v156, s44, v156
    v_mfma_f32_16x16x32_bf16 v[48:51], a[160:163], v[140:143], v[48:51]
    v_or3_b32 v252, v252, v152, v157
    v_or3_b32 v252, v252, v158, v159
    v_bitop3_b32 v252, v252, v156, v236 bitop3:0x54
    v_mfma_f32_16x16x32_bf16 v[52:55], a[164:167], v[140:143], v[52:55]
    buffer_load_dwordx4 v[216:219], v27, s[28:31], s9 offen offset:0 sc1
    v_cmp_ne_u32 vcc, 0, v252
    v_mfma_f32_16x16x32_bf16 v[56:59], a[168:171], v[140:143], v[56:59]
    v_mul_f32 v97, v97, v101
    v_exp_f32 v226, -v226
    v_mfma_f32_16x16x32_bf16 v[60:63], a[172:175], v[140:143], v[60:63]
    s_cbranch_vccnz L_ar_01
L_arr_01:
    v_mul_f32 v98, v98, v102
    v_exp_f32 v227, -v227
    v_mfma_f32_16x16x32_bf16 v[64:67], a[112:115], v[144:147], 0
    v_mul_f32 v99, v99, v103
    v_fma_f32 v224, v224, v250, v250
    v_fma_f32 v225, v225, v250, v250
    v_mfma_f32_16x16x32_bf16 v[68:71], a[116:119], v[144:147], 0
    buffer_load_dwordx4 v[220:223], v27, s[28:31], s9 offen offset:256 sc1
    v_fma_f32 v226, v226, v250, v250
    v_mfma_f32_16x16x32_bf16 v[72:75], a[120:123], v[144:147], 0
    v_fma_f32 v227, v227, v250, v250
    v_rcp_f32 v224, v224
    v_mfma_f32_16x16x32_bf16 v[76:79], a[124:127], v[144:147], 0
    buffer_load_dwordx4 v[128:131], v24, s[28:31], s11 offen offset:0 sc1
    v_rcp_f32 v225, v225
    v_mfma_f32_16x16x32_bf16 v[112:115], a[112:115], v[148:151], 0
    v_rcp_f32 v226, v226
    v_rcp_f32 v227, v227
    v_mfma_f32_16x16x32_bf16 v[116:119], a[116:119], v[148:151], 0
    buffer_load_dwordx4 v[132:135], v24, s[28:31], s11 offen offset:256 sc1
    v_mul_f32 v224, v224, v96
    v_mfma_f32_16x16x32_bf16 v[120:123], a[120:123], v[148:151], 0
    v_mul_f32 v225, v225, v97
    v_mul_f32 v226, v226, v98
    v_mul_f32 v227, v227, v99
    v_mfma_f32_16x16x32_bf16 v[124:127], a[124:127], v[148:151], 0
    v_cvt_pk_bf16_f32 v8, v224, v225
    v_cvt_pk_bf16_f32 v9, v226, v227
    v_and_or_b32 v8, v8, v236, v249
    v_mfma_f32_16x16x32_bf16 v[64:67], a[128:131], v[152:155], v[64:67]
    s_waitcnt vmcnt(15)
    v_xor_b32 v160, s44, v160
    v_or3_b32 v252, v161, v162, v163
    v_mfma_f32_16x16x32_bf16 v[68:71], a[132:135], v[152:155], v[68:71]
    buffer_load_dwordx4 v[136:139], v25, s[28:31], s11 offen offset:0 sc1
    v_xor_b32 v164, s44, v164
    v_mfma_f32_16x16x32_bf16 v[72:75], a[136:139], v[152:155], v[72:75]
    v_or3_b32 v252, v252, v160, v165
    v_or3_b32 v252, v252, v166, v167
    v_xor_b32 v168, s44, v168
    v_mfma_f32_16x16x32_bf16 v[76:79], a[140:143], v[152:155], v[76:79]
    v_or3_b32 v252, v252, v164, v169
    v_or3_b32 v252, v252, v170, v171
    v_xor_b32 v172, s44, v172
    v_mfma_f32_16x16x32_bf16 v[112:115], a[128:131], v[156:159], v[112:115]
    v_or3_b32 v252, v252, v168, v173
    v_or3_b32 v252, v252, v174, v175
    v_bitop3_b32 v252, v252, v172, v236 bitop3:0x54
    v_mfma_f32_16x16x32_bf16 v[116:119], a[132:135], v[156:159], v[116:119]
    buffer_load_dwordx4 v[140:143], v25, s[28:31], s11 offen offset:256 sc1
    v_cmp_ne_u32 vcc, 0, v252
    v_mfma_f32_16x16x32_bf16 v[120:123], a[136:139], v[156:159], v[120:123]
    v_and_b32 v9, v236, v9
    v_fmaak_f32 v228, v104, v104, 0x409d30fc
    v_fmaak_f32 v229, v105, v105, 0x409d30fc
    v_mfma_f32_16x16x32_bf16 v[124:127], a[140:143], v[156:159], v[124:127]
    s_cbranch_vccnz L_ar_10
L_arr_10:
    v_fmaak_f32 v230, v106, v106, 0x409d30fc
    v_fmaak_f32 v231, v107, v107, 0x409d30fc
    v_mfma_f32_16x16x32_bf16 v[32:35], a[176:179], v[160:163], v[32:35]
    v_mul_f32 v228, v228, v104
    v_mul_f32 v229, v229, v105
    v_mul_f32 v230, v230, v106
    v_mfma_f32_16x16x32_bf16 v[36:39], a[180:183], v[160:163], v[36:39]
    s_add_u32 m0, s67, 86016
    s_add_u32 s7, s52, 0
    buffer_load_dwordx4 v240, s[36:39], s7 offen offset:0 lds
    v_mfma_f32_16x16x32_bf16 v[40:43], a[184:187], v[160:163], v[40:43]
    v_mul_f32 v231, v231, v107
    v_exp_f32 v228, -v228
    v_mfma_f32_16x16x32_bf16 v[44:47], a[188:191], v[160:163], v[44:47]
    buffer_load_dwordx4 v241, s[36:39], s7 offen offset:1024 lds
    v_mul_f32 v104, v104, v108
    v_mfma_f32_16x16x32_bf16 v[48:51], a[176:179], v[164:167], v[48:51]
    v_exp_f32 v229, -v229
    v_mul_f32 v105, v105, v109
    v_mfma_f32_16x16x32_bf16 v[52:55], a[180:183], v[164:167], v[52:55]
    buffer_load_dwordx4 v242, s[36:39], s7 offen offset:2048 lds
    v_exp_f32 v230, -v230
    v_mfma_f32_16x16x32_bf16 v[56:59], a[184:187], v[164:167], v[56:59]
    v_mul_f32 v106, v106, v110
    v_exp_f32 v231, -v231
    v_mfma_f32_16x16x32_bf16 v[60:63], a[188:191], v[164:167], v[60:63]
    v_mul_f32 v107, v107, v111
    v_fma_f32 v228, v228, v250, v250
    v_fma_f32 v229, v229, v250, v250
    v_mfma_f32_16x16x32_bf16 v[32:35], a[192:195], v[168:171], v[32:35]
    s_waitcnt vmcnt(16)
    v_xor_b32 v176, s44, v176
    v_or3_b32 v252, v177, v178, v179
    v_mfma_f32_16x16x32_bf16 v[36:39], a[196:199], v[168:171], v[36:39]
    buffer_load_dwordx4 v243, s[36:39], s7 offen offset:3072 lds
    v_xor_b32 v180, s44, v180
    v_mfma_f32_16x16x32_bf16 v[40:43], a[200:203], v[168:171], v[40:43]
    v_or3_b32 v252, v252, v176, v181
    v_or3_b32 v252, v252, v182, v183
    v_xor_b32 v184, s44, v184
    v_mfma_f32_16x16x32_bf16 v[44:47], a[204:207], v[168:171], v[44:47]
    v_or3_b32 v252, v252, v180, v185
    v_or3_b32 v252, v252, v186, v187
    v_xor_b32 v188, s44, v188
    v_mfma_f32_16x16x32_bf16 v[48:51], a[192:195], v[172:175], v[48:51]
    v_or3_b32 v252, v252, v184, v189
    v_or3_b32 v252, v252, v190, v191
    v_bitop3_b32 v252, v252, v188, v236 bitop3:0x54
    v_mfma_f32_16x16x32_bf16 v[52:55], a[196:199], v[172:175], v[52:55]
    buffer_load_dwordx4 v[144:147], v26, s[28:31], s10 offen offset:0 sc1
    v_cmp_ne_u32 vcc, 0, v252
    v_mfma_f32_16x16x32_bf16 v[56:59], a[200:203], v[172:175], v[56:59]
    v_fma_f32 v230, v230, v250, v250
    v_fma_f32 v231, v231, v250, v250
    v_rcp_f32 v228, v228
    v_mfma_f32_16x16x32_bf16 v[60:63], a[204:207], v[172:175], v[60:63]
    s_cbranch_vccnz L_ar_11
L_arr_11:
    v_rcp_f32 v229, v229
    v_mfma_f32_16x16x32_bf16 v[64:67], a[144:147], v[176:179], v[64:67]
    v_rcp_f32 v230, v230
    v_rcp_f32 v231, v231
    v_mfma_f32_16x16x32_bf16 v[68:71], a[148:151], v[176:179], v[68:71]
    buffer_load_dwordx4 v[148:151], v26, s[28:31], s10 offen offset:256 sc1
    v_mul_f32 v228, v228, v104
    v_mfma_f32_16x16x32_bf16 v[72:75], a[152:155], v[176:179], v[72:75]
    v_mul_f32 v229, v229, v105
    v_mul_f32 v230, v230, v106
    v_mul_f32 v231, v231, v107
    v_mfma_f32_16x16x32_bf16 v[76:79], a[156:159], v[176:179], v[76:79]
    buffer_load_dwordx4 v[152:155], v27, s[28:31], s10 offen offset:0 sc1
    v_cvt_pk_bf16_f32 v10, v228, v229
    v_mfma_f32_16x16x32_bf16 v[112:115], a[144:147], v[180:183], v[112:115]
    v_cvt_pk_bf16_f32 v11, v230, v231
    v_and_or_b32 v10, v10, v236, v249
    v_and_b32 v11, v236, v11
    v_mfma_f32_16x16x32_bf16 v[116:119], a[148:151], v[180:183], v[116:119]
    buffer_load_dwordx4 v[156:159], v27, s[28:31], s10 offen offset:256 sc1
    v_permlane16_swap_b32 v8, v10
    v_mfma_f32_16x16x32_bf16 v[120:123], a[152:155], v[180:183], v[120:123]
    v_permlane16_swap_b32 v9, v11
    buffer_store_dwordx4 v[8:11], v4, s[28:31], s59 offen sc1
    v_mfma_f32_16x16x32_bf16 v[124:127], a[156:159], v[180:183], v[124:127]
    v_mfma_f32_16x16x32_bf16 v[64:67], a[160:163], v[184:187], v[64:67]
    s_waitcnt vmcnt(17)
    v_xor_b32 v192, s44, v192
    v_or3_b32 v252, v193, v194, v195
    v_mfma_f32_16x16x32_bf16 v[68:71], a[164:167], v[184:187], v[68:71]
    s_add_u32 m0, s67, 114688
    s_add_u32 s7, s53, 0
    buffer_load_dwordx4 v240, s[36:39], s7 offen offset:0 lds
    v_xor_b32 v196, s44, v196
    v_mfma_f32_16x16x32_bf16 v[72:75], a[168:171], v[184:187], v[72:75]
    v_or3_b32 v252, v252, v192, v197
    v_or3_b32 v252, v252, v198, v199
    v_xor_b32 v200, s44, v200
    v_mfma_f32_16x16x32_bf16 v[76:79], a[172:175], v[184:187], v[76:79]
    v_or3_b32 v252, v252, v196, v201
    v_or3_b32 v252, v252, v202, v203
    v_xor_b32 v204, s44, v204
    v_mfma_f32_16x16x32_bf16 v[112:115], a[160:163], v[188:191], v[112:115]
    v_or3_b32 v252, v252, v200, v205
    v_or3_b32 v252, v252, v206, v207
    v_bitop3_b32 v252, v252, v204, v236 bitop3:0x54
    v_mfma_f32_16x16x32_bf16 v[116:119], a[164:167], v[188:191], v[116:119]
    buffer_load_dwordx4 v241, s[36:39], s7 offen offset:1024 lds
    v_cmp_ne_u32 vcc, 0, v252
    v_mfma_f32_16x16x32_bf16 v[120:123], a[168:171], v[188:191], v[120:123]
    v_mfma_f32_16x16x32_bf16 v[124:127], a[172:175], v[188:191], v[124:127]
    s_cbranch_vccnz L_ar_20
L_arr_20:
    v_mfma_f32_16x16x32_bf16 v[32:35], a[208:211], v[192:195], v[32:35]
    ds_read_b64_tr_b16 a[0:1], v244 offset:0
    ds_read_b64_tr_b16 a[2:3], v244 offset:512
    v_mfma_f32_16x16x32_bf16 v[36:39], a[212:215], v[192:195], v[36:39]
    buffer_load_dwordx4 v242, s[36:39], s7 offen offset:2048 lds
    v_mfma_f32_16x16x32_bf16 v[40:43], a[216:219], v[192:195], v[40:43]
    ds_read_b64_tr_b16 a[4:5], v245 offset:0
    ds_read_b64_tr_b16 a[6:7], v245 offset:512
    v_mfma_f32_16x16x32_bf16 v[44:47], a[220:223], v[192:195], v[44:47]
    buffer_load_dwordx4 v243, s[36:39], s7 offen offset:3072 lds
    v_mfma_f32_16x16x32_bf16 v[48:51], a[208:211], v[196:199], v[48:51]
    ds_read_b64_tr_b16 a[8:9], v246 offset:0
    ds_read_b64_tr_b16 a[10:11], v246 offset:512
    v_mfma_f32_16x16x32_bf16 v[52:55], a[212:215], v[196:199], v[52:55]
    buffer_load_dwordx4 v[160:163], v24, s[28:31], s12 offen offset:0 sc1
    v_mfma_f32_16x16x32_bf16 v[56:59], a[216:219], v[196:199], v[56:59]
    ds_read_b64_tr_b16 a[12:13], v247 offset:0
    ds_read_b64_tr_b16 a[14:15], v247 offset:512
    v_mfma_f32_16x16x32_bf16 v[60:63], a[220:223], v[196:199], v[60:63]
    v_mfma_f32_16x16x32_bf16 v[32:35], a[224:227], v[200:203], v[32:35]
    s_waitcnt vmcnt(18)
    v_xor_b32 v208, s44, v208
    v_or3_b32 v252, v209, v210, v211
    v_mfma_f32_16x16x32_bf16 v[36:39], a[228:231], v[200:203], v[36:39]
    buffer_load_dwordx4 v[164:167], v24, s[28:31], s12 offen offset:256 sc1
    v_xor_b32 v212, s44, v212
    v_mfma_f32_16x16x32_bf16 v[40:43], a[232:235], v[200:203], v[40:43]
    v_or3_b32 v252, v252, v208, v213
    v_or3_b32 v252, v252, v214, v215
    v_xor_b32 v216, s44, v216
    v_mfma_f32_16x16x32_bf16 v[44:47], a[236:239], v[200:203], v[44:47]
    v_or3_b32 v252, v252, v212, v217
    v_or3_b32 v252, v252, v218, v219
    v_xor_b32 v220, s44, v220
    v_mfma_f32_16x16x32_bf16 v[48:51], a[224:227], v[204:207], v[48:51]
    v_or3_b32 v252, v252, v216, v221
    v_or3_b32 v252, v252, v222, v223
    v_bitop3_b32 v252, v252, v220, v236 bitop3:0x54
    v_mfma_f32_16x16x32_bf16 v[52:55], a[228:231], v[204:207], v[52:55]
    buffer_load_dwordx4 v[168:171], v25, s[28:31], s12 offen offset:0 sc1
    v_cmp_ne_u32 vcc, 0, v252
    v_mfma_f32_16x16x32_bf16 v[56:59], a[232:235], v[204:207], v[56:59]
    v_mfma_f32_16x16x32_bf16 v[60:63], a[236:239], v[204:207], v[60:63]
    s_cbranch_vccnz L_ar_21
L_arr_21:
    v_mfma_f32_16x16x32_bf16 v[64:67], a[176:179], v[208:211], v[64:67]
    ds_read_b64_tr_b16 a[32:33], v28 offset:16384
    ds_read_b64_tr_b16 a[34:35], v28 offset:16896
    v_mfma_f32_16x16x32_bf16 v[68:71], a[180:183], v[208:211], v[68:71]
    buffer_load_dwordx4 v[172:175], v25, s[28:31], s12 offen offset:256 sc1
    v_mfma_f32_16x16x32_bf16 v[72:75], a[184:187], v[208:211], v[72:75]
    ds_read_b64_tr_b16 a[36:37], v29 offset:16384
    ds_read_b64_tr_b16 a[38:39], v29 offset:16896
    v_mfma_f32_16x16x32_bf16 v[76:79], a[188:191], v[208:211], v[76:79]
    s_add_u32 m0, s67, 131072
    s_add_u32 s7, s53, 114688
    buffer_load_dwordx4 v240, s[36:39], s7 offen offset:0 lds
    v_mfma_f32_16x16x32_bf16 v[112:115], a[176:179], v[212:215], v[112:115]
    ds_read_b64_tr_b16 a[40:41], v30 offset:16384
    ds_read_b64_tr_b16 a[42:43], v30 offset:16896
    v_mfma_f32_16x16x32_bf16 v[116:119], a[180:183], v[212:215], v[116:119]
    buffer_load_dwordx4 v241, s[36:39], s7 offen offset:1024 lds
    v_mfma_f32_16x16x32_bf16 v[120:123], a[184:187], v[212:215], v[120:123]
    ds_read_b64_tr_b16 a[44:45], v31 offset:16384
    ds_read_b64_tr_b16 a[46:47], v31 offset:16896
    v_mfma_f32_16x16x32_bf16 v[124:127], a[188:191], v[212:215], v[124:127]
    v_mfma_f32_16x16x32_bf16 v[64:67], a[192:195], v[216:219], v[64:67]
    s_waitcnt vmcnt(19)
    v_xor_b32 v128, s44, v128
    v_or3_b32 v252, v129, v130, v131
    v_mfma_f32_16x16x32_bf16 v[68:71], a[196:199], v[216:219], v[68:71]
    buffer_load_dwordx4 v242, s[36:39], s7 offen offset:2048 lds
    v_xor_b32 v132, s44, v132
    v_mfma_f32_16x16x32_bf16 v[72:75], a[200:203], v[216:219], v[72:75]
    v_or3_b32 v252, v252, v128, v133
    v_or3_b32 v252, v252, v134, v135
    v_xor_b32 v136, s44, v136
    v_mfma_f32_16x16x32_bf16 v[76:79], a[204:207], v[216:219], v[76:79]
    v_or3_b32 v252, v252, v132, v137
    v_or3_b32 v252, v252, v138, v139
    v_xor_b32 v140, s44, v140
    v_mfma_f32_16x16x32_bf16 v[112:115], a[192:195], v[220:223], v[112:115]
    v_or3_b32 v252, v252, v136, v141
    v_or3_b32 v252, v252, v142, v143
    v_bitop3_b32 v252, v252, v140, v236 bitop3:0x54
    v_mfma_f32_16x16x32_bf16 v[116:119], a[196:199], v[220:223], v[116:119]
    buffer_load_dwordx4 v243, s[36:39], s7 offen offset:3072 lds
    v_cmp_ne_u32 vcc, 0, v252
    v_mfma_f32_16x16x32_bf16 v[120:123], a[200:203], v[220:223], v[120:123]
    v_mfma_f32_16x16x32_bf16 v[124:127], a[204:207], v[220:223], v[124:127]
    s_cbranch_vccnz L_ar_30
L_arr_30:
    v_mfma_f32_16x16x32_bf16 v[32:35], a[240:243], v[128:131], v[32:35]
    s_waitcnt vmcnt(17)
    ds_read_b64_tr_b16 a[16:17], v244 offset:28672
    ds_read_b64_tr_b16 a[18:19], v244 offset:29184
    v_mfma_f32_16x16x32_bf16 v[36:39], a[244:247], v[128:131], v[36:39]
    buffer_load_dwordx4 v[192:195], v24, s[28:31], s13 offen offset:0 sc1
    v_mfma_f32_16x16x32_bf16 v[40:43], a[248:251], v[128:131], v[40:43]
    ds_read_b64_tr_b16 a[20:21], v245 offset:28672
    ds_read_b64_tr_b16 a[22:23], v245 offset:29184
    v_mfma_f32_16x16x32_bf16 v[44:47], a[252:255], v[128:131], v[44:47]
    buffer_load_dwordx4 v[196:199], v24, s[28:31], s13 offen offset:256 sc1
    v_mfma_f32_16x16x32_bf16 v[48:51], a[240:243], v[132:135], v[48:51]
    ds_read_b64_tr_b16 a[24:25], v246 offset:28672
    ds_read_b64_tr_b16 a[26:27], v246 offset:29184
    v_mfma_f32_16x16x32_bf16 v[52:55], a[244:247], v[132:135], v[52:55]
    buffer_load_dwordx4 v[200:203], v25, s[28:31], s13 offen offset:0 sc1
    v_mfma_f32_16x16x32_bf16 v[56:59], a[248:251], v[132:135], v[56:59]
    ds_read_b64_tr_b16 a[28:29], v247 offset:28672
    ds_read_b64_tr_b16 a[30:31], v247 offset:29184
    v_mfma_f32_16x16x32_bf16 v[60:63], a[252:255], v[132:135], v[60:63]
    s_waitcnt lgkmcnt(15)
    v_mfma_f32_16x16x32_bf16 v[32:35], a[0:3], v[136:139], v[32:35]
    s_waitcnt vmcnt(16)
    v_xor_b32 v144, s44, v144
    v_or3_b32 v252, v145, v146, v147
    v_mfma_f32_16x16x32_bf16 v[36:39], a[4:7], v[136:139], v[36:39]
    buffer_load_dwordx4 v[204:207], v25, s[28:31], s13 offen offset:256 sc1
    v_xor_b32 v148, s44, v148
    v_mfma_f32_16x16x32_bf16 v[40:43], a[8:11], v[136:139], v[40:43]
    v_or3_b32 v252, v252, v144, v149
    v_or3_b32 v252, v252, v150, v151
    v_xor_b32 v152, s44, v152
    v_mfma_f32_16x16x32_bf16 v[44:47], a[12:15], v[136:139], v[44:47]
    v_or3_b32 v252, v252, v148, v153
    v_or3_b32 v252, v252, v154, v155
    v_xor_b32 v156, s44, v156
    v_mfma_f32_16x16x32_bf16 v[48:51], a[0:3], v[140:143], v[48:51]
    v_or3_b32 v252, v252, v152, v157
    v_or3_b32 v252, v252, v158, v159
    v_bitop3_b32 v252, v252, v156, v236 bitop3:0x54
    v_mfma_f32_16x16x32_bf16 v[52:55], a[4:7], v[140:143], v[52:55]
    buffer_load_dwordx4 v[128:131], v24, s[28:31], s14 offen offset:0 sc1
    v_cmp_ne_u32 vcc, 0, v252
    v_mfma_f32_16x16x32_bf16 v[56:59], a[8:11], v[140:143], v[56:59]
    v_mfma_f32_16x16x32_bf16 v[60:63], a[12:15], v[140:143], v[60:63]
    s_cbranch_vccnz L_ar_31
L_arr_31:
    v_mfma_f32_16x16x32_bf16 v[64:67], a[208:211], v[144:147], v[64:67]
    s_waitcnt vmcnt(13)
    ds_read_b64_tr_b16 a[48:49], v244 offset:57344
    ds_read_b64_tr_b16 a[50:51], v244 offset:57856
    v_mfma_f32_16x16x32_bf16 v[68:71], a[212:215], v[144:147], v[68:71]
    buffer_load_dwordx4 v[132:135], v24, s[28:31], s14 offen offset:256 sc1
    v_mfma_f32_16x16x32_bf16 v[72:75], a[216:219], v[144:147], v[72:75]
    ds_read_b64_tr_b16 a[52:53], v245 offset:57344
    ds_read_b64_tr_b16 a[54:55], v245 offset:57856
    v_mfma_f32_16x16x32_bf16 v[76:79], a[220:223], v[144:147], v[76:79]
    buffer_load_dwordx4 v[136:139], v25, s[28:31], s14 offen offset:0 sc1
    v_mfma_f32_16x16x32_bf16 v[112:115], a[208:211], v[148:151], v[112:115]
    ds_read_b64_tr_b16 a[56:57], v246 offset:57344
    ds_read_b64_tr_b16 a[58:59], v246 offset:57856
    v_mfma_f32_16x16x32_bf16 v[116:119], a[212:215], v[148:151], v[116:119]
    buffer_load_dwordx4 v[140:143], v25, s[28:31], s14 offen offset:256 sc1
    v_mfma_f32_16x16x32_bf16 v[120:123], a[216:219], v[148:151], v[120:123]
    ds_read_b64_tr_b16 a[60:61], v247 offset:57344
    ds_read_b64_tr_b16 a[62:63], v247 offset:57856
    v_mfma_f32_16x16x32_bf16 v[124:127], a[220:223], v[148:151], v[124:127]
    v_mfma_f32_16x16x32_bf16 v[64:67], a[224:227], v[152:155], v[64:67]
    s_waitcnt vmcnt(12)
    v_xor_b32 v160, s44, v160
    v_or3_b32 v252, v161, v162, v163
    v_mfma_f32_16x16x32_bf16 v[68:71], a[228:231], v[152:155], v[68:71]
    buffer_load_dwordx4 v[176:179], v26, s[28:31], s11 offen offset:0 sc1
    v_xor_b32 v164, s44, v164
    v_mfma_f32_16x16x32_bf16 v[72:75], a[232:235], v[152:155], v[72:75]
    v_or3_b32 v252, v252, v160, v165
    v_or3_b32 v252, v252, v166, v167
    v_xor_b32 v168, s44, v168
    v_mfma_f32_16x16x32_bf16 v[76:79], a[236:239], v[152:155], v[76:79]
    v_or3_b32 v252, v252, v164, v169
    v_or3_b32 v252, v252, v170, v171
    v_xor_b32 v172, s44, v172
    v_mfma_f32_16x16x32_bf16 v[112:115], a[224:227], v[156:159], v[112:115]
    v_or3_b32 v252, v252, v168, v173
    v_or3_b32 v252, v252, v174, v175
    v_bitop3_b32 v252, v252, v172, v236 bitop3:0x54
    v_mfma_f32_16x16x32_bf16 v[116:119], a[228:231], v[156:159], v[116:119]
    buffer_load_dwordx4 v[180:183], v26, s[28:31], s11 offen offset:256 sc1
    v_cmp_ne_u32 vcc, 0, v252
    v_mfma_f32_16x16x32_bf16 v[120:123], a[232:235], v[156:159], v[120:123]
    v_mfma_f32_16x16x32_bf16 v[124:127], a[236:239], v[156:159], v[124:127]
    s_cbranch_vccnz L_ar_40
L_arr_40:
    s_waitcnt lgkmcnt(8)
    v_mfma_f32_16x16x32_bf16 v[32:35], a[16:19], v[160:163], v[32:35]
    s_waitcnt vmcnt(10)
    ds_read_b64_tr_b16 a[64:65], v28 offset:0
    ds_read_b64_tr_b16 a[66:67], v28 offset:512
    v_mfma_f32_16x16x32_bf16 v[36:39], a[20:23], v[160:163], v[36:39]
    buffer_load_dwordx4 v[184:187], v27, s[28:31], s11 offen offset:0 sc1
    v_mfma_f32_16x16x32_bf16 v[40:43], a[24:27], v[160:163], v[40:43]
    ds_read_b64_tr_b16 a[68:69], v29 offset:0
    ds_read_b64_tr_b16 a[70:71], v29 offset:512
    v_mfma_f32_16x16x32_bf16 v[44:47], a[28:31], v[160:163], v[44:47]
    buffer_load_dwordx4 v[188:191], v27, s[28:31], s11 offen offset:256 sc1
    v_mfma_f32_16x16x32_bf16 v[48:51], a[16:19], v[164:167], v[48:51]
    ds_read_b64_tr_b16 a[72:73], v30 offset:0
    ds_read_b64_tr_b16 a[74:75], v30 offset:512
    v_mfma_f32_16x16x32_bf16 v[52:55], a[20:23], v[164:167], v[52:55]
    buffer_load_dwordx4 v[208:211], v26, s[28:31], s12 offen offset:0 sc1
    v_mfma_f32_16x16x32_bf16 v[56:59], a[24:27], v[164:167], v[56:59]
    ds_read_b64_tr_b16 a[76:77], v31 offset:0
    ds_read_b64_tr_b16 a[78:79], v31 offset:512
    v_mfma_f32_16x16x32_bf16 v[60:63], a[28:31], v[164:167], v[60:63]
    v_mfma_f32_16x16x32_bf16 v[32:35], a[32:35], v[168:171], v[32:35]
    s_waitcnt vmcnt(9)
    v_xor_b32 v192, s44, v192
    v_or3_b32 v252, v193, v194, v195
    v_mfma_f32_16x16x32_bf16 v[36:39], a[36:39], v[168:171], v[36:39]
    buffer_load_dwordx4 v[212:215], v26, s[28:31], s12 offen offset:256 sc1
    v_xor_b32 v196, s44, v196
    v_mfma_f32_16x16x32_bf16 v[40:43], a[40:43], v[168:171], v[40:43]
    v_or3_b32 v252, v252, v192, v197
    v_or3_b32 v252, v252, v198, v199
    v_xor_b32 v200, s44, v200
    v_mfma_f32_16x16x32_bf16 v[44:47], a[44:47], v[168:171], v[44:47]
    v_or3_b32 v252, v252, v196, v201
    v_or3_b32 v252, v252, v202, v203
    v_xor_b32 v204, s44, v204
    v_mfma_f32_16x16x32_bf16 v[48:51], a[32:35], v[172:175], v[48:51]
    v_or3_b32 v252, v252, v200, v205
    v_or3_b32 v252, v252, v206, v207
    v_bitop3_b32 v252, v252, v204, v236 bitop3:0x54
    v_mfma_f32_16x16x32_bf16 v[52:55], a[36:39], v[172:175], v[52:55]
    buffer_load_dwordx4 v[216:219], v27, s[28:31], s12 offen offset:0 sc1
    v_cmp_ne_u32 vcc, 0, v252
    v_mfma_f32_16x16x32_bf16 v[56:59], a[40:43], v[172:175], v[56:59]
    v_mfma_f32_16x16x32_bf16 v[60:63], a[44:47], v[172:175], v[60:63]
    s_cbranch_vccnz L_ar_50
L_arr_50:
    s_waitcnt lgkmcnt(8)
    v_mfma_f32_16x16x32_bf16 v[32:35], a[48:51], v[192:195], v[32:35]
    v_mfma_f32_16x16x32_bf16 v[36:39], a[52:55], v[192:195], v[36:39]
    buffer_load_dwordx4 v[220:223], v27, s[28:31], s12 offen offset:256 sc1
    v_mfma_f32_16x16x32_bf16 v[40:43], a[56:59], v[192:195], v[40:43]
    v_mfma_f32_16x16x32_bf16 v[44:47], a[60:63], v[192:195], v[44:47]
    buffer_load_dwordx4 v[144:147], v26, s[28:31], s13 offen offset:0 sc1
    v_mfma_f32_16x16x32_bf16 v[48:51], a[48:51], v[196:199], v[48:51]
    v_mfma_f32_16x16x32_bf16 v[52:55], a[52:55], v[196:199], v[52:55]
    buffer_load_dwordx4 v[148:151], v26, s[28:31], s13 offen offset:256 sc1
    v_mfma_f32_16x16x32_bf16 v[56:59], a[56:59], v[196:199], v[56:59]
    v_mfma_f32_16x16x32_bf16 v[60:63], a[60:63], v[196:199], v[60:63]
    s_waitcnt lgkmcnt(0)
    v_mfma_f32_16x16x32_bf16 v[32:35], a[64:67], v[200:203], v[32:35]
    s_waitcnt vmcnt(10)
    v_xor_b32 v128, s44, v128
    v_or3_b32 v252, v129, v130, v131
    v_mfma_f32_16x16x32_bf16 v[36:39], a[68:71], v[200:203], v[36:39]
    buffer_load_dwordx4 v[152:155], v27, s[28:31], s13 offen offset:0 sc1
    v_xor_b32 v132, s44, v132
    v_mfma_f32_16x16x32_bf16 v[40:43], a[72:75], v[200:203], v[40:43]
    v_or3_b32 v252, v252, v128, v133
    v_or3_b32 v252, v252, v134, v135
    v_xor_b32 v136, s44, v136
    v_mfma_f32_16x16x32_bf16 v[44:47], a[76:79], v[200:203], v[44:47]
    v_or3_b32 v252, v252, v132, v137
    v_or3_b32 v252, v252, v138, v139
    v_xor_b32 v140, s44, v140
    v_mfma_f32_16x16x32_bf16 v[48:51], a[64:67], v[204:207], v[48:51]
    v_or3_b32 v252, v252, v136, v141
    v_or3_b32 v252, v252, v142, v143
    v_bitop3_b32 v252, v252, v140, v236 bitop3:0x54
    v_mfma_f32_16x16x32_bf16 v[52:55], a[68:71], v[204:207], v[52:55]
    buffer_load_dwordx4 v[156:159], v27, s[28:31], s13 offen offset:256 sc1
    v_cmp_ne_u32 vcc, 0, v252
    v_mfma_f32_16x16x32_bf16 v[56:59], a[72:75], v[204:207], v[56:59]
    v_mfma_f32_16x16x32_bf16 v[60:63], a[76:79], v[204:207], v[60:63]
    s_cbranch_vccnz L_ar_60
L_arr_60:
    v_mfma_f32_16x16x32_bf16 v[32:35], a[112:115], v[128:131], v[32:35]
    v_mfma_f32_16x16x32_bf16 v[36:39], a[116:119], v[128:131], v[36:39]
    buffer_load_dwordx4 v[80:83], v5, s[28:31], s46 offen sc1
    v_mfma_f32_16x16x32_bf16 v[40:43], a[120:123], v[128:131], v[40:43]
    v_mfma_f32_16x16x32_bf16 v[44:47], a[124:127], v[128:131], v[44:47]
    v_mfma_f32_16x16x32_bf16 v[48:51], a[112:115], v[132:135], v[48:51]
    v_mfma_f32_16x16x32_bf16 v[52:55], a[116:119], v[132:135], v[52:55]
    buffer_load_dwordx4 v[84:87], v5, s[28:31], s21 offen sc1
    v_mfma_f32_16x16x32_bf16 v[56:59], a[120:123], v[132:135], v[56:59]
    v_mfma_f32_16x16x32_bf16 v[60:63], a[124:127], v[132:135], v[60:63]
    v_mfma_f32_16x16x32_bf16 v[32:35], a[128:131], v[136:139], v[32:35]
    s_waitcnt vmcnt(10)
    v_xor_b32 v176, s44, v176
    v_or3_b32 v252, v177, v178, v179
    v_mfma_f32_16x16x32_bf16 v[36:39], a[132:135], v[136:139], v[36:39]
    v_xor_b32 v180, s44, v180
    v_mfma_f32_16x16x32_bf16 v[40:43], a[136:139], v[136:139], v[40:43]
    v_or3_b32 v252, v252, v176, v181
    v_or3_b32 v252, v252, v182, v183
    v_xor_b32 v184, s44, v184
    v_mfma_f32_16x16x32_bf16 v[44:47], a[140:143], v[136:139], v[44:47]
    v_or3_b32 v252, v252, v180, v185
    v_or3_b32 v252, v252, v186, v187
    v_xor_b32 v188, s44, v188
    v_mfma_f32_16x16x32_bf16 v[48:51], a[128:131], v[140:143], v[48:51]
    v_or3_b32 v252, v252, v184, v189
    v_or3_b32 v252, v252, v190, v191
    v_bitop3_b32 v252, v252, v188, v236 bitop3:0x54
    v_mfma_f32_16x16x32_bf16 v[52:55], a[132:135], v[140:143], v[52:55]
    v_cmp_ne_u32 vcc, 0, v252
    v_mfma_f32_16x16x32_bf16 v[56:59], a[136:139], v[140:143], v[56:59]
    v_mfma_f32_16x16x32_bf16 v[60:63], a[140:143], v[140:143], v[60:63]
    s_cbranch_vccnz L_ar_41
L_arr_41:
    v_mfma_f32_16x16x32_bf16 v[64:67], a[240:243], v[176:179], v[64:67]
    v_mfma_f32_16x16x32_bf16 v[68:71], a[244:247], v[176:179], v[68:71]
    ds_write_b128 v248, v[32:35] offset:0
    v_mfma_f32_16x16x32_bf16 v[72:75], a[248:251], v[176:179], v[72:75]
    v_mfma_f32_16x16x32_bf16 v[76:79], a[252:255], v[176:179], v[76:79]
    v_mfma_f32_16x16x32_bf16 v[112:115], a[240:243], v[180:183], v[112:115]
    v_mfma_f32_16x16x32_bf16 v[116:119], a[244:247], v[180:183], v[116:119]
    ds_write_b128 v255, v[36:39] offset:1024
    v_mfma_f32_16x16x32_bf16 v[120:123], a[248:251], v[180:183], v[120:123]
    v_mfma_f32_16x16x32_bf16 v[124:127], a[252:255], v[180:183], v[124:127]
    v_mfma_f32_16x16x32_bf16 v[64:67], a[0:3], v[184:187], v[64:67]
    s_waitcnt vmcnt(6)
    v_xor_b32 v208, s44, v208
    v_or3_b32 v252, v209, v210, v211
    v_mfma_f32_16x16x32_bf16 v[68:71], a[4:7], v[184:187], v[68:71]
    v_xor_b32 v212, s44, v212
    ds_write_b128 v248, v[40:43] offset:2048
    v_mfma_f32_16x16x32_bf16 v[72:75], a[8:11], v[184:187], v[72:75]
    v_or3_b32 v252, v252, v208, v213
    v_or3_b32 v252, v252, v214, v215
    v_xor_b32 v216, s44, v216
    v_mfma_f32_16x16x32_bf16 v[76:79], a[12:15], v[184:187], v[76:79]
    v_or3_b32 v252, v252, v212, v217
    v_or3_b32 v252, v252, v218, v219
    v_xor_b32 v220, s44, v220
    v_mfma_f32_16x16x32_bf16 v[112:115], a[0:3], v[188:191], v[112:115]
    v_or3_b32 v252, v252, v216, v221
    v_or3_b32 v252, v252, v222, v223
    v_bitop3_b32 v252, v252, v220, v236 bitop3:0x54
    v_mfma_f32_16x16x32_bf16 v[116:119], a[4:7], v[188:191], v[116:119]
    v_cmp_ne_u32 vcc, 0, v252
    ds_write_b128 v255, v[44:47] offset:3072
    v_mfma_f32_16x16x32_bf16 v[120:123], a[8:11], v[188:191], v[120:123]
    v_mfma_f32_16x16x32_bf16 v[124:127], a[12:15], v[188:191], v[124:127]
    s_cbranch_vccnz L_ar_51
L_arr_51:
    v_mfma_f32_16x16x32_bf16 v[64:67], a[16:19], v[208:211], v[64:67]
    s_waitcnt vmcnt(2)
    v_xor_b32 v144, s44, v144
    v_or3_b32 v252, v145, v146, v147
    v_mfma_f32_16x16x32_bf16 v[68:71], a[20:23], v[208:211], v[68:71]
    v_xor_b32 v148, s44, v148
    ds_write_b128 v248, v[48:51] offset:4096
    v_mfma_f32_16x16x32_bf16 v[72:75], a[24:27], v[208:211], v[72:75]
    v_or3_b32 v252, v252, v144, v149
    v_or3_b32 v252, v252, v150, v151
    v_xor_b32 v152, s44, v152
    v_mfma_f32_16x16x32_bf16 v[76:79], a[28:31], v[208:211], v[76:79]
    v_or3_b32 v252, v252, v148, v153
    v_or3_b32 v252, v252, v154, v155
    v_xor_b32 v156, s44, v156
    v_mfma_f32_16x16x32_bf16 v[64:67], a[32:35], v[216:219], v[64:67]
    v_or3_b32 v252, v252, v152, v157
    v_or3_b32 v252, v252, v158, v159
    v_bitop3_b32 v252, v252, v156, v236 bitop3:0x54
L_pad5:
    s_cbranch_execz L_pad9
    v_mfma_f32_16x16x32_bf16 v[68:71], a[36:39], v[216:219], v[68:71]
    v_cmp_ne_u32 vcc, 0, v252
    ds_write_b128 v255, v[52:55] offset:5120
    v_mfma_f32_16x16x32_bf16 v[72:75], a[40:43], v[216:219], v[72:75]
    v_mfma_f32_16x16x32_bf16 v[76:79], a[44:47], v[216:219], v[76:79]
    s_cbranch_vccnz L_ar_61
L_arr_61:
    v_mfma_f32_16x16x32_bf16 v[64:67], a[48:51], v[144:147], v[64:67]
    s_waitcnt vmcnt(0)
    ds_bpermute_b32 v88, v6, v80
    ds_bpermute_b32 v89, v6, v81
    v_mfma_f32_16x16x32_bf16 v[68:71], a[52:55], v[144:147], v[68:71]
    ds_write_b128 v248, v[56:59] offset:6144
    v_mfma_f32_16x16x32_bf16 v[72:75], a[56:59], v[144:147], v[72:75]
    ds_bpermute_b32 v90, v6, v82
    ds_bpermute_b32 v91, v6, v83
    v_mfma_f32_16x16x32_bf16 v[76:79], a[60:63], v[144:147], v[76:79]
    ds_write_b128 v255, v[60:63] offset:7168
    v_mfma_f32_16x16x32_bf16 v[64:67], a[64:67], v[152:155], v[64:67]
    ds_bpermute_b32 v92, v6, v84
    ds_bpermute_b32 v93, v6, v85
    v_mfma_f32_16x16x32_bf16 v[68:71], a[68:71], v[152:155], v[68:71]
    v_mfma_f32_16x16x32_bf16 v[72:75], a[72:75], v[152:155], v[72:75]
    ds_bpermute_b32 v94, v6, v86
    ds_bpermute_b32 v95, v6, v87
    v_mfma_f32_16x16x32_bf16 v[76:79], a[76:79], v[152:155], v[76:79]
    s_waitcnt lgkmcnt(0)
    s_barrier
    v_mfma_f32_16x16x32_bf16 v[112:115], a[16:19], v[212:215], v[112:115]
    ds_read_b128 v[128:131], v15 offset:0
    v_mfma_f32_16x16x32_bf16 v[116:119], a[20:23], v[212:215], v[116:119]
    ds_read_b128 v[132:135], v15 offset:256
    v_mfma_f32_16x16x32_bf16 v[120:123], a[24:27], v[212:215], v[120:123]
    ds_read_b128 v[136:139], v15 offset:8192
    v_mfma_f32_16x16x32_bf16 v[124:127], a[28:31], v[212:215], v[124:127]
    ds_read_b128 v[140:143], v15 offset:8448
    v_mfma_f32_16x16x32_bf16 v[112:115], a[32:35], v[220:223], v[112:115]
    ds_read_b128 v[160:163], v15 offset:16384
    v_mfma_f32_16x16x32_bf16 v[116:119], a[36:39], v[220:223], v[116:119]
    ds_read_b128 v[164:167], v15 offset:16640
    v_mfma_f32_16x16x32_bf16 v[120:123], a[40:43], v[220:223], v[120:123]
    ds_read_b128 v[168:171], v15 offset:24576
    v_mfma_f32_16x16x32_bf16 v[124:127], a[44:47], v[220:223], v[124:127]
    ds_read_b128 v[172:175], v15 offset:24832
    ds_write_b128 v248, v[64:67] offset:32768
    v_mfma_f32_16x16x32_bf16 v[112:115], a[48:51], v[148:151], v[112:115]
    v_lshlrev_b32 v192, 16, v88
    v_and_b32 v193, 0xffff0000, v88
    v_lshlrev_b32 v194, 16, v89
    v_mfma_f32_16x16x32_bf16 v[116:119], a[52:55], v[148:151], v[116:119]
    v_and_b32 v195, 0xffff0000, v89
    v_lshlrev_b32 v196, 16, v90
    v_mfma_f32_16x16x32_bf16 v[120:123], a[56:59], v[148:151], v[120:123]
    v_and_b32 v197, 0xffff0000, v90
    v_lshlrev_b32 v198, 16, v91
    v_and_b32 v199, 0xffff0000, v91
    v_mfma_f32_16x16x32_bf16 v[124:127], a[60:63], v[148:151], v[124:127]
    s_waitcnt lgkmcnt(5)
    v_add_f32 v128, v128, v136
    ds_write_b128 v255, v[68:71] offset:33792
    v_mfma_f32_16x16x32_bf16 v[112:115], a[64:67], v[156:159], v[112:115]
    v_add_f32 v129, v129, v137
    v_add_f32 v130, v130, v138
    v_add_f32 v131, v131, v139
    v_mfma_f32_16x16x32_bf16 v[116:119], a[68:71], v[156:159], v[116:119]
    v_add_f32 v132, v132, v140
    v_add_f32 v133, v133, v141
    v_mfma_f32_16x16x32_bf16 v[120:123], a[72:75], v[156:159], v[120:123]
    v_add_f32 v134, v134, v142
    v_add_f32 v135, v135, v143
    s_waitcnt lgkmcnt(2)
    v_mfma_f32_16x16x32_bf16 v[124:127], a[76:79], v[156:159], v[124:127]
    v_add_f32 v160, v160, v168
    v_add_f32 v161, v161, v169
    ds_write_b128 v248, v[72:75] offset:34816
    v_add_f32 v162, v162, v170
    v_add_f32 v163, v163, v171
    v_add_f32 v164, v164, v172
    v_add_f32 v165, v165, v173
    v_add_f32 v166, v166, v174
    v_add_f32 v167, v167, v175
    v_add_f32 v128, v128, v160
    v_add_f32 v129, v129, v161
    v_add_f32 v130, v130, v162
    ds_write_b128 v255, v[76:79] offset:35840
    v_add_f32 v131, v131, v163
    v_add_f32 v132, v132, v164
    v_add_f32 v133, v133, v165
    v_add_f32 v134, v134, v166
    v_add_f32 v135, v135, v167
    v_fma_f32 v128, v128, v16, v192
    v_fma_f32 v129, v129, v17, v193
    v_fma_f32 v130, v130, v18, v194
    v_fma_f32 v131, v131, v19, v195
    ds_write_b128 v248, v[112:115] offset:36864
    v_fma_f32 v132, v132, v20, v196
    v_fma_f32 v133, v133, v21, v197
    v_fma_f32 v134, v134, v22, v198
    v_fma_f32 v135, v135, v23, v199
    v_cvt_pk_bf16_f32 v8, v128, v129
    v_cvt_pk_bf16_f32 v9, v130, v131
    v_cvt_pk_bf16_f32 v10, v132, v133
    v_cvt_pk_bf16_f32 v11, v134, v135
    buffer_store_dwordx4 v[8:11], v7, s[40:43], s100 offen sc1
    ds_write_b128 v255, v[116:119] offset:37888
    v_lshlrev_b32 v200, 16, v92
    v_and_b32 v201, 0xffff0000, v92
    v_lshlrev_b32 v202, 16, v93
    v_and_b32 v203, 0xffff0000, v93
    v_lshlrev_b32 v204, 16, v94
    v_and_b32 v205, 0xffff0000, v94
    v_lshlrev_b32 v206, 16, v95
    v_and_b32 v207, 0xffff0000, v95
    ds_write_b128 v248, v[120:123] offset:38912
    ds_write_b128 v255, v[124:127] offset:39936
    s_waitcnt lgkmcnt(0)
    s_barrier
    ds_read_b128 v[128:131], v15 offset:32768
    ds_read_b128 v[132:135], v15 offset:33024
    ds_read_b128 v[136:139], v15 offset:40960
    ds_read_b128 v[140:143], v15 offset:41216
    ds_read_b128 v[160:163], v15 offset:49152
    ds_read_b128 v[164:167], v15 offset:49408
    ds_read_b128 v[168:171], v15 offset:57344
    ds_read_b128 v[172:175], v15 offset:57600
    s_waitcnt lgkmcnt(4)
    v_pk_add_f32 v[128:129], v[128:129], v[136:137]
    v_pk_add_f32 v[130:131], v[130:131], v[138:139]
    v_pk_add_f32 v[132:133], v[132:133], v[140:141]
    v_pk_add_f32 v[134:135], v[134:135], v[142:143]
    s_waitcnt lgkmcnt(0)
    v_pk_add_f32 v[160:161], v[160:161], v[168:169]
    v_pk_add_f32 v[162:163], v[162:163], v[170:171]
    v_pk_add_f32 v[164:165], v[164:165], v[172:173]
    v_pk_add_f32 v[166:167], v[166:167], v[174:175]
    v_pk_add_f32 v[128:129], v[128:129], v[160:161]
    v_pk_add_f32 v[130:131], v[130:131], v[162:163]
    v_pk_add_f32 v[132:133], v[132:133], v[164:165]
    v_pk_add_f32 v[134:135], v[134:135], v[166:167]
    v_pk_fma_f32 v[128:129], v[128:129], v[16:17], v[200:201]
    v_pk_fma_f32 v[130:131], v[130:131], v[18:19], v[202:203]
    v_pk_fma_f32 v[132:133], v[132:133], v[20:21], v[204:205]
    v_pk_fma_f32 v[134:135], v[134:135], v[22:23], v[206:207]
    v_cvt_pk_bf16_f32 v24, v128, v129
    v_cvt_pk_bf16_f32 v25, v130, v131
    v_cvt_pk_bf16_f32 v26, v132, v133
    v_cvt_pk_bf16_f32 v27, v134, v135
    buffer_store_dwordx4 v[24:27], v0, s[40:43], s100 offen sc1
L_fin:
L_end:
    s_endpgm
L_notmain:
    s_sub_u32 s50, s17, 16
    s_lshr_b32 s48, s50, 1
    s_lshl_b32 s48, s48, 3
    s_add_u32 s48, s48, s16
    s_lshl_b32 s48, s48, 1
    s_and_b32 s50, s50, 1
    s_add_u32 s48, s48, s50
    v_lshrrev_b32 v68, 2, v1
    v_and_b32 v69, 3, v1
    v_bfe_u32 v70, v1, 4, 1
    v_lshlrev_b32 v70, 1, v70
    v_xor_b32 v69, v69, v70
    v_mul_u32_u24 v68, 5376, v68
    v_lshl_add_u32 v68, v69, 4, v68
    s_mul_i32 s50, s20, 602112
    s_lshl_b32 s51, s48, 6
    s_add_u32 s50, s50, s51
    s_mul_i32 s53, s20, 7168
    s_add_u32 s53, s53, 114688
    s_bitcmp1_b32 s48, 0
    s_cselect_b32 s51, 516096, 0
    s_cselect_b32 s52, 6144, 0
    s_add_u32 s50, s50, s51
    s_add_u32 s53, s53, s52
    s_bitcmp1_b32 s48, 0
    s_mov_b32 s51, 86016
    s_mov_b32 s52, 1024
    s_cselect_b32 s51, -86016, s51
    s_cselect_b32 s52, -1024, s52
    v_lshlrev_b32 v69, 2, v0
    s_waitcnt lgkmcnt(0)
    s_mov_b32 s28, s6
    s_and_b32 s29, s7, 0xffff
    s_mov_b32 s30, 0x1000000
    s_mov_b32 s31, 0x20000
    s_cmp_ge_u32 s48, 84
    s_cbranch_scc1 L_idle
    s_mov_b32 s40, s14
    s_and_b32 s41, s15, 0xffff
    s_mov_b32 s42, 0x380
    s_mov_b32 s43, 0x20000
    s_mov_b32 s44, s60
    s_and_b32 s45, s61, 0xffff
    s_mov_b32 s46, 0x24c000
    s_mov_b32 s47, 0x20000
    buffer_load_dword v70, v69, s[40:43], 0 offen
    s_mov_b32 m0, s53
    s_add_u32 s53, s53, s52
    buffer_load_dwordx4 v68, s[44:47], s50 offen lds
    s_add_u32 s50, s50, s51
    s_mov_b32 m0, s53
    s_add_u32 s53, s53, s52
    buffer_load_dwordx4 v68, s[44:47], s50 offen lds
    s_add_u32 s50, s50, s51
    s_mov_b32 m0, s53
    s_add_u32 s53, s53, s52
    buffer_load_dwordx4 v68, s[44:47], s50 offen lds
    s_add_u32 s50, s50, s51
    s_mov_b32 m0, s53
    s_add_u32 s53, s53, s52
    buffer_load_dwordx4 v68, s[44:47], s50 offen lds
    s_add_u32 s50, s50, s51
    s_mov_b32 m0, s53
    s_add_u32 s53, s53, s52
    buffer_load_dwordx4 v68, s[44:47], s50 offen lds
    s_add_u32 s50, s50, s51
    s_mov_b32 m0, s53
    s_add_u32 s53, s53, s52
    buffer_load_dwordx4 v68, s[44:47], s50 offen lds
    s_add_u32 s50, s50, s51
    s_mov_b32 m0, s53
    s_add_u32 s53, s53, s52
    buffer_load_dwordx4 v68, s[44:47], s50 offen lds
    s_add_u32 s50, s50, s51
    s_add_u32 s54, s6, 0x220000
    s_addc_u32 s55, s7, 0
    s_load_dword s56, s[54:55], 0
    s_mov_b32 s24, s4
    s_and_b32 s25, s5, 0xffff
    s_mov_b32 s26, 0x1c0000
    s_mov_b32 s27, 0x20000
    v_and_b32 v92, 0xf1, v0
    v_bfe_u32 v93, v0, 1, 2
    v_lshl_add_u32 v92, v93, 2, v92
    v_bfe_u32 v93, v0, 3, 1
    v_lshl_add_u32 v92, v93, 1, v92
    v_lshlrev_b32 v92, 2, v92
    v_add_u32 v92, 143360, v92
    v_lshrrev_b32 v93, 2, v1
    v_lshlrev_b32 v93, 6, v93
    v_xor_b32 v94, s20, v5
    v_and_b32 v94, 1, v94
    v_lshl_add_u32 v93, v94, 5, v93
    v_and_b32 v94, 3, v1
    v_lshl_add_u32 v93, v94, 3, v93
    v_add_u32 v93, 114688, v93
    v_lshlrev_b32 v94, 4, v5
    v_add_u32 v94, 143360, v94
    s_lshr_b32 s54, s48, 1
    s_mul_i32 s54, s54, 37
    s_lshr_b32 s54, s54, 8
    s_mov_b32 s53, 0
    s_cmp_eq_u32 s54, 1
    s_cselect_b32 s53, 1.0, s53
    s_cmp_eq_u32 s54, 4
    s_cselect_b32 s53, 1.0, s53
    s_lshl_b32 s52, s48, 7
    s_lshl_b32 s54, s20, 6
    s_add_u32 s52, s52, s54
    s_add_u32 s52, s52, 0x200000
    v_lshlrev_b32 v95, 2, v1
    v_cvt_f32_u32 v90, v7
    v_mul_f32 v77, 0x3b124925, v90
    v_mul_f32 v78, 0x3b924925, v90
    v_mul_f32 v79, 0x3bdb6db7, v90
    v_cos_f32 v32, v77
    v_sin_f32 v33, v77
    v_cos_f32 v34, v78
    v_sin_f32 v35, v78
    v_cos_f32 v36, v79
    v_sin_f32 v37, v79
    v_mul_f32 v90, 0x3c800000, v90
    v_mul_f32 v91, v90, v42
    v_fmamk_f32 v76, v90, 0x00000000, v91
    v_fmamk_f32 v77, v90, 0x3f800000, v91
    v_fmamk_f32 v78, v90, 0x40000000, v91
    v_fmamk_f32 v79, v90, 0x40400000, v91
    v_cos_f32 v80, v76
    v_sin_f32 v84, v76
    v_cos_f32 v81, v77
    v_sin_f32 v85, v77
    v_cos_f32 v82, v78
    v_sin_f32 v86, v78
    v_cos_f32 v83, v79
    v_sin_f32 v87, v79
    v_cvt_pk_bf16_f32 v16, v80, v84
    v_cvt_pk_bf16_f32 v17, v81, v85
    v_cvt_pk_bf16_f32 v18, v82, v86
    v_cvt_pk_bf16_f32 v19, v83, v87
    v_fmamk_f32 v76, v90, 0x41800000, v91
    v_fmamk_f32 v77, v90, 0x41880000, v91
    v_fmamk_f32 v78, v90, 0x41900000, v91
    v_fmamk_f32 v79, v90, 0x41980000, v91
    v_cos_f32 v80, v76
    v_sin_f32 v84, v76
    v_cos_f32 v81, v77
    v_sin_f32 v85, v77
    v_cos_f32 v82, v78
    v_sin_f32 v86, v78
    v_cos_f32 v83, v79
    v_sin_f32 v87, v79
    v_cvt_pk_bf16_f32 v20, v80, v84
    v_cvt_pk_bf16_f32 v21, v81, v85
    v_cvt_pk_bf16_f32 v22, v82, v86
    v_cvt_pk_bf16_f32 v23, v83, v87
    v_fmamk_f32 v76, v90, 0x42000000, v91
    v_fmamk_f32 v77, v90, 0x42040000, v91
    v_fmamk_f32 v78, v90, 0x42080000, v91
    v_fmamk_f32 v79, v90, 0x420c0000, v91
    v_cos_f32 v80, v76
    v_sin_f32 v84, v76
    v_cos_f32 v81, v77
    v_sin_f32 v85, v77
    v_cos_f32 v82, v78
    v_sin_f32 v86, v78
    v_cos_f32 v83, v79
    v_sin_f32 v87, v79
    v_cvt_pk_bf16_f32 v24, v80, v84
    v_cvt_pk_bf16_f32 v25, v81, v85
    v_cvt_pk_bf16_f32 v26, v82, v86
    v_cvt_pk_bf16_f32 v27, v83, v87
    v_fmamk_f32 v76, v90, 0x42400000, v91
    v_fmamk_f32 v77, v90, 0x42440000, v91
    v_fmamk_f32 v78, v90, 0x42480000, v91
    v_fmamk_f32 v79, v90, 0x424c0000, v91
    v_cos_f32 v80, v76
    v_sin_f32 v84, v76
    v_cos_f32 v81, v77
    v_sin_f32 v85, v77
    v_cos_f32 v82, v78
    v_sin_f32 v86, v78
    v_cos_f32 v83, v79
    v_sin_f32 v87, v79
    v_cvt_pk_bf16_f32 v28, v80, v84
    v_cvt_pk_bf16_f32 v29, v81, v85
    v_cvt_pk_bf16_f32 v30, v82, v86
    v_cvt_pk_bf16_f32 v31, v83, v87
    v_and_b32 v80, 2, v40
    v_xor_b32 v81, v41, v80
    v_mul_u32_u24 v61, 896, v40
    v_lshl_add_u32 v61, v81, 4, v61
    v_bfe_u32 v81, v1, 2, 2
    v_lshl_add_u32 v82, v5, 3, v81
    v_lshlrev_b32 v82, 7, v82
    v_and_b32 v83, 3, v1
    v_lshl_add_u32 v82, v83, 3, v82
    v_lshrrev_b32 v83, 1, v81
    v_and_b32 v80, 1, v5
    v_lshl_add_u32 v83, v80, 1, v83
    v_lshl_add_u32 v62, v83, 5, v82
    s_lshl_b32 s55, s20, 5
    v_xor_b32 v39, s55, v62
    v_add_u32 v63, 57344, v39
    v_lshlrev_b32 v3, 2, v7
    v_mul_u32_u24 v49, 1088, v5
    v_add_u32 v49, v49, v3
    v_add_u32 v49, 114688, v49
    v_mul_u32_u24 v50, 272, v6
    v_lshl_add_u32 v50, v5, 4, v50
    v_add_u32 v50, 114688, v50
    v_lshlrev_b32 v51, 11, v41
    v_and_b32 v80, 1, v41
    v_lshl_add_u32 v51, v80, 7, v51
    v_bfe_u32 v80, v41, 1, 1
    v_lshl_add_u32 v51, v80, 6, v51
    v_lshrrev_b32 v80, 2, v41
    v_lshl_add_u32 v51, v80, 4, v51
    v_lshl_add_u32 v51, v40, 5, v51
    s_mul_i32 s55, s20, 448
    s_add_u32 s54, s55, 123392
    v_add_u32 v51, s54, v51
    s_add_u32 s54, s55, 3584
    v_add_u32 v47, s54, v4
    v_lshlrev_b32 v59, 5, v41
    v_add_u32 v59, 141824, v59
    v_lshl_add_u32 v58, v5, 4, v59
    s_lshl_b32 s54, s20, 2
    v_add_u32 v58, s54, v58
    s_mul_i32 s54, s20, 1536
    s_add_u32 s54, s54, 154624
    v_add_u32 v44, s54, v4
    v_cmp_gt_u32 vcc, 28, v1
    v_mov_b32 v80, 0x30000
    s_nop 0
    v_cndmask_b32 v44, v80, v44, vcc
    v_lshlrev_b32 v45, 5, v40
    v_add_u32 v45, s54, v45
    v_mul_u32_u24 v43, 896, v41
    v_lshl_add_u32 v43, v40, 4, v43
    s_mul_i32 s54, s20, 224
    s_add_u32 s54, s54, 147456
    v_add_u32 v43, s54, v43
    s_waitcnt vmcnt(7)
    v_lshlrev_b32 v96, 16, v70
    v_and_b32 v97, 0xffff0000, v70
    v_mul_f32 v98, 0xbfb8aa3b, v96
    v_mul_f32 v99, 0xbfb8aa3b, v97
    v_exp_f32 v98, v98
    v_exp_f32 v99, v99
    v_add_f32 v98, 1.0, v98
    v_add_f32 v99, 1.0, v99
    v_rcp_f32 v98, v98
    v_rcp_f32 v99, v99
    v_mul_f32 v96, v96, v98
    v_mul_f32 v97, v97, v99
    v_cvt_pk_bf16_f32 v96, v96, v97
    ds_write_b32 v92, v96
    s_waitcnt lgkmcnt(0)
    s_add_u32 s56, s56, 0x10001
    s_and_b32 s56, s56, 0x9fff9fff
    s_or_b32 s56, s56, 0x20002000
    s_and_b32 s57, s56, 0xffff0000
    s_and_b32 s58, s56, 0xffff
    s_waitcnt vmcnt(0)
    s_barrier
    s_cmp_ge_u32 s20, 2
    s_cbranch_scc1 L_other2
    ds_read_b128 v[128:131], v94 offset:0
    ds_read_b64_tr_b16 v[192:193], v93 offset:0
    ds_read_b64_tr_b16 v[194:195], v93 offset:1024
    ds_read_b128 v[132:135], v94 offset:64
    ds_read_b64_tr_b16 v[196:197], v93 offset:2048
    ds_read_b64_tr_b16 v[198:199], v93 offset:3072
    ds_read_b128 v[136:139], v94 offset:128
    ds_read_b64_tr_b16 v[200:201], v93 offset:4096
    ds_read_b64_tr_b16 v[202:203], v93 offset:5120
    ds_read_b128 v[140:143], v94 offset:192
    ds_read_b64_tr_b16 v[204:205], v93 offset:6144
    ds_read_b64_tr_b16 v[206:207], v93 offset:7168
    ds_read_b128 v[144:147], v94 offset:256
    ds_read_b64_tr_b16 v[208:209], v93 offset:8192
    ds_read_b64_tr_b16 v[210:211], v93 offset:9216
    s_waitcnt lgkmcnt(12)
    v_mfma_f32_16x16x32_bf16 v[96:99], v[128:131], v[192:195], 0
    ds_read_b128 v[148:151], v94 offset:320
    ds_read_b64_tr_b16 v[212:213], v93 offset:10240
    ds_read_b64_tr_b16 v[214:215], v93 offset:11264
    s_waitcnt lgkmcnt(12)
    v_mfma_f32_16x16x32_bf16 v[96:99], v[132:135], v[196:199], v[96:99]
    ds_read_b128 v[152:155], v94 offset:384
    ds_read_b64_tr_b16 v[216:217], v93 offset:12288
    ds_read_b64_tr_b16 v[218:219], v93 offset:13312
    s_waitcnt lgkmcnt(12)
    v_mfma_f32_16x16x32_bf16 v[96:99], v[136:139], v[200:203], v[96:99]
    ds_read_b128 v[156:159], v94 offset:448
    ds_read_b64_tr_b16 v[220:221], v93 offset:14336
    ds_read_b64_tr_b16 v[222:223], v93 offset:15360
    s_waitcnt lgkmcnt(12)
    v_mfma_f32_16x16x32_bf16 v[96:99], v[140:143], v[204:207], v[96:99]
    ds_read_b128 v[160:163], v94 offset:512
    ds_read_b64_tr_b16 v[224:225], v93 offset:16384
    ds_read_b64_tr_b16 v[226:227], v93 offset:17408
    s_waitcnt lgkmcnt(12)
    v_mfma_f32_16x16x32_bf16 v[96:99], v[144:147], v[208:211], v[96:99]
    ds_read_b128 v[164:167], v94 offset:576
    ds_read_b64_tr_b16 v[228:229], v93 offset:18432
    ds_read_b64_tr_b16 v[230:231], v93 offset:19456
    s_waitcnt lgkmcnt(12)
    v_mfma_f32_16x16x32_bf16 v[96:99], v[148:151], v[212:215], v[96:99]
    ds_read_b128 v[168:171], v94 offset:640
    ds_read_b64_tr_b16 v[232:233], v93 offset:20480
    ds_read_b64_tr_b16 v[234:235], v93 offset:21504
    s_waitcnt lgkmcnt(12)
    v_mfma_f32_16x16x32_bf16 v[96:99], v[152:155], v[216:219], v[96:99]
    ds_read_b128 v[172:175], v94 offset:704
    ds_read_b64_tr_b16 v[236:237], v93 offset:22528
    ds_read_b64_tr_b16 v[238:239], v93 offset:23552
    s_waitcnt lgkmcnt(12)
    v_mfma_f32_16x16x32_bf16 v[96:99], v[156:159], v[220:223], v[96:99]
    ds_read_b128 v[176:179], v94 offset:768
    ds_read_b64_tr_b16 v[240:241], v93 offset:24576
    ds_read_b64_tr_b16 v[242:243], v93 offset:25600
    s_waitcnt lgkmcnt(12)
    v_mfma_f32_16x16x32_bf16 v[96:99], v[160:163], v[224:227], v[96:99]
    ds_read_b128 v[180:183], v94 offset:832
    ds_read_b64_tr_b16 v[244:245], v93 offset:26624
    ds_read_b64_tr_b16 v[246:247], v93 offset:27648
    s_waitcnt lgkmcnt(12)
    v_mfma_f32_16x16x32_bf16 v[96:99], v[164:167], v[228:231], v[96:99]
    s_waitcnt lgkmcnt(9)
    v_mfma_f32_16x16x32_bf16 v[96:99], v[168:171], v[232:235], v[96:99]
    s_waitcnt lgkmcnt(6)
    v_mfma_f32_16x16x32_bf16 v[96:99], v[172:175], v[236:239], v[96:99]
    s_waitcnt lgkmcnt(3)
    v_mfma_f32_16x16x32_bf16 v[96:99], v[176:179], v[240:243], v[96:99]
    s_waitcnt lgkmcnt(0)
    v_mfma_f32_16x16x32_bf16 v[96:99], v[180:183], v[244:247], v[96:99]
    s_nop 7
    v_cvt_pk_bf16_f32 v96, v96, v96
    v_lshlrev_b32 v96, 16, v96
    v_add_f32 v96, s53, v96
    v_cvt_pk_bf16_f32 v96, v96, v96
    v_lshlrev_b32 v96, 16, v96
    v_or_b32 v96, s58, v96
    s_mov_b64 exec, 0xffff
    buffer_store_dword v96, v95, s[28:31], s52 offen sc1
    s_mov_b64 exec, -1
    s_branch L_other2
L_idle:
    s_add_u32 s54, s6, 0x220000
    s_addc_u32 s55, s7, 0
    s_load_dword s56, s[54:55], 0
    s_mov_b32 s24, s4
    s_and_b32 s25, s5, 0xffff
    s_mov_b32 s26, 0x1c0000
    s_mov_b32 s27, 0x20000
    v_cvt_f32_u32 v90, v7
    v_mul_f32 v77, 0x3b124925, v90
    v_mul_f32 v78, 0x3b924925, v90
    v_mul_f32 v79, 0x3bdb6db7, v90
    v_cos_f32 v32, v77
    v_sin_f32 v33, v77
    v_cos_f32 v34, v78
    v_sin_f32 v35, v78
    v_cos_f32 v36, v79
    v_sin_f32 v37, v79
    v_mul_f32 v90, 0x3c800000, v90
    v_mul_f32 v91, v90, v42
    v_fmamk_f32 v76, v90, 0x00000000, v91
    v_fmamk_f32 v77, v90, 0x3f800000, v91
    v_fmamk_f32 v78, v90, 0x40000000, v91
    v_fmamk_f32 v79, v90, 0x40400000, v91
    v_cos_f32 v80, v76
    v_sin_f32 v84, v76
    v_cos_f32 v81, v77
    v_sin_f32 v85, v77
    v_cos_f32 v82, v78
    v_sin_f32 v86, v78
    v_cos_f32 v83, v79
    v_sin_f32 v87, v79
    v_cvt_pk_bf16_f32 v16, v80, v84
    v_cvt_pk_bf16_f32 v17, v81, v85
    v_cvt_pk_bf16_f32 v18, v82, v86
    v_cvt_pk_bf16_f32 v19, v83, v87
    v_fmamk_f32 v76, v90, 0x41800000, v91
    v_fmamk_f32 v77, v90, 0x41880000, v91
    v_fmamk_f32 v78, v90, 0x41900000, v91
    v_fmamk_f32 v79, v90, 0x41980000, v91
    v_cos_f32 v80, v76
    v_sin_f32 v84, v76
    v_cos_f32 v81, v77
    v_sin_f32 v85, v77
    v_cos_f32 v82, v78
    v_sin_f32 v86, v78
    v_cos_f32 v83, v79
    v_sin_f32 v87, v79
    v_cvt_pk_bf16_f32 v20, v80, v84
    v_cvt_pk_bf16_f32 v21, v81, v85
    v_cvt_pk_bf16_f32 v22, v82, v86
    v_cvt_pk_bf16_f32 v23, v83, v87
    v_fmamk_f32 v76, v90, 0x42000000, v91
    v_fmamk_f32 v77, v90, 0x42040000, v91
    v_fmamk_f32 v78, v90, 0x42080000, v91
    v_fmamk_f32 v79, v90, 0x420c0000, v91
    v_cos_f32 v80, v76
    v_sin_f32 v84, v76
    v_cos_f32 v81, v77
    v_sin_f32 v85, v77
    v_cos_f32 v82, v78
    v_sin_f32 v86, v78
    v_cos_f32 v83, v79
    v_sin_f32 v87, v79
    v_cvt_pk_bf16_f32 v24, v80, v84
    v_cvt_pk_bf16_f32 v25, v81, v85
    v_cvt_pk_bf16_f32 v26, v82, v86
    v_cvt_pk_bf16_f32 v27, v83, v87
    v_fmamk_f32 v76, v90, 0x42400000, v91
    v_fmamk_f32 v77, v90, 0x42440000, v91
    v_fmamk_f32 v78, v90, 0x42480000, v91
    v_fmamk_f32 v79, v90, 0x424c0000, v91
    v_cos_f32 v80, v76
    v_sin_f32 v84, v76
    v_cos_f32 v81, v77
    v_sin_f32 v85, v77
    v_cos_f32 v82, v78
    v_sin_f32 v86, v78
    v_cos_f32 v83, v79
    v_sin_f32 v87, v79
    v_cvt_pk_bf16_f32 v28, v80, v84
    v_cvt_pk_bf16_f32 v29, v81, v85
    v_cvt_pk_bf16_f32 v30, v82, v86
    v_cvt_pk_bf16_f32 v31, v83, v87
    v_and_b32 v80, 2, v40
    v_xor_b32 v81, v41, v80
    v_mul_u32_u24 v61, 896, v40
    v_lshl_add_u32 v61, v81, 4, v61
    v_bfe_u32 v81, v1, 2, 2
    v_lshl_add_u32 v82, v5, 3, v81
    v_lshlrev_b32 v82, 7, v82
    v_and_b32 v83, 3, v1
    v_lshl_add_u32 v82, v83, 3, v82
    v_lshrrev_b32 v83, 1, v81
    v_and_b32 v80, 1, v5
    v_lshl_add_u32 v83, v80, 1, v83
    v_lshl_add_u32 v62, v83, 5, v82
    s_lshl_b32 s55, s20, 5
    v_xor_b32 v39, s55, v62
    v_add_u32 v63, 57344, v39
    v_lshlrev_b32 v3, 2, v7
    v_mul_u32_u24 v49, 1088, v5
    v_add_u32 v49, v49, v3
    v_add_u32 v49, 114688, v49
    v_mul_u32_u24 v50, 272, v6
    v_lshl_add_u32 v50, v5, 4, v50
    v_add_u32 v50, 114688, v50
    v_lshlrev_b32 v51, 11, v41
    v_and_b32 v80, 1, v41
    v_lshl_add_u32 v51, v80, 7, v51
    v_bfe_u32 v80, v41, 1, 1
    v_lshl_add_u32 v51, v80, 6, v51
    v_lshrrev_b32 v80, 2, v41
    v_lshl_add_u32 v51, v80, 4, v51
    v_lshl_add_u32 v51, v40, 5, v51
    s_mul_i32 s55, s20, 448
    s_add_u32 s54, s55, 123392
    v_add_u32 v51, s54, v51
    s_add_u32 s54, s55, 3584
    v_add_u32 v47, s54, v4
    v_lshlrev_b32 v59, 5, v41
    v_add_u32 v59, 141824, v59
    v_lshl_add_u32 v58, v5, 4, v59
    s_lshl_b32 s54, s20, 2
    v_add_u32 v58, s54, v58
    s_mul_i32 s54, s20, 1536
    s_add_u32 s54, s54, 154624
    v_add_u32 v44, s54, v4
    v_cmp_gt_u32 vcc, 28, v1
    v_mov_b32 v80, 0x30000
    s_nop 0
    v_cndmask_b32 v44, v80, v44, vcc
    v_lshlrev_b32 v45, 5, v40
    v_add_u32 v45, s54, v45
    v_mul_u32_u24 v43, 896, v41
    v_lshl_add_u32 v43, v40, 4, v43
    s_mul_i32 s54, s20, 224
    s_add_u32 s54, s54, 147456
    v_add_u32 v43, s54, v43
    s_waitcnt lgkmcnt(0)
    s_add_u32 s56, s56, 0x10001
    s_and_b32 s56, s56, 0x9fff9fff
    s_or_b32 s56, s56, 0x20002000
    s_and_b32 s57, s56, 0xffff0000
    s_and_b32 s58, s56, 0xffff
L_other2:
    v_mov_b32 v65, 0
    v_mov_b32 v184, 0
    v_mov_b32 v206, 0
    s_mov_b64 exec, 0
    s_cmp_eq_u32 s20, 0
    s_cbranch_scc1 L_pad0
    s_cmp_eq_u32 s20, 1
    s_cbranch_scc1 L_pad1
    s_cmp_eq_u32 s20, 2
    s_cbranch_scc1 L_pad2
    s_branch L_pad3
L_padret2:
    s_lshr_b32 s54, s17, 3
    s_and_b32 s55, s54, 1
    s_lshl1_add_u32 s40, s16, s55
    s_sub_u32 s55, 32, s40
    s_cmp_eq_u32 s55, 32
    s_cselect_b32 s55, 16, s55
    s_cmp_lt_u32 s54, 2
    s_cselect_b32 s40, s40, s55
    s_and_b32 s41, s17, 7
    s_lshl3_add_u32 s21, s40, s41
    s_lshl_b32 s36, s41, 8
    s_add_u32 s36, s36, s40
    s_sub_u32 s54, s36, 992
    s_and_b32 s55, s21, 0xfc
    s_cmp_eq_u32 s55, 4
    s_cselect_b32 s36, s54, s36
    s_cselect_b32 s37, 0, -1
    s_cselect_b32 s38, 0, 0xbe800000
    s_cmp_eq_u32 s55, 0
    s_cselect_b32 s39, 0, -1
    s_lshl_b32 s54, s20, 6
    s_add_u32 s48, s36, s54
    s_sub_u32 s49, 2048, s48
    s_cmp_eq_u32 s48, 0
    s_cselect_b32 s49, 1024, s49
    s_mul_i32 s48, s48, 896
    s_mul_i32 s49, s49, 896
    s_mul_i32 s50, s20, 1792
    s_add_u32 s50, s50, 147456
    v_lshlrev_b32 v2, 13, v5
    v_lshl_add_u32 v2, v7, 4, v2
    s_lshr_b32 s54, s21, 3
    s_lshl_b32 s54, s54, 16
    v_add_u32 v2, s54, v2
    s_lshl_b32 s54, s16, 11
    s_add_u32 s54, s54, 0x230000
    v_lshlrev_b32 v48, 7, v6
    v_add_u32 v48, s54, v48
    s_branch L_join
L_spec1:
L_pad6:
    s_cbranch_execz L_padret
    s_mov_b32 s69, 0
L_sachk:
    v_xor_b32 v253, s58, v192
    v_bitop3_b32 v253, v193, s58, v253 bitop3:0xbe
    v_bitop3_b32 v253, v194, s58, v253 bitop3:0xbe
    v_bitop3_b32 v253, v195, s58, v253 bitop3:0xbe
    v_bitop3_b32 v253, v196, s58, v253 bitop3:0xbe
    v_bitop3_b32 v253, v197, s58, v253 bitop3:0xbe
    v_bitop3_b32 v253, v198, s58, v253 bitop3:0xbe
    v_lshlrev_b32 v253, 16, v253
    v_cmp_ne_u32 vcc, 0, v253
    s_nop 0
    s_cbranch_vccz L_saok
    s_add_u32 s69, s69, 1
    s_cmp_gt_u32 s69, 400000
    s_cbranch_scc1 L_saok
    buffer_load_dword v192, v3, s[28:31], s7 offen offset:0 sc1
    buffer_load_dword v193, v3, s[28:31], s7 offen offset:256 sc1
    buffer_load_dword v194, v3, s[28:31], s7 offen offset:512 sc1
    buffer_load_dword v195, v3, s[28:31], s7 offen offset:768 sc1
    buffer_load_dword v196, v3, s[28:31], s7 offen offset:1024 sc1
    buffer_load_dword v197, v3, s[28:31], s7 offen offset:1280 sc1
    buffer_load_dword v198, v3, s[28:31], s7 offen offset:1536 sc1
    s_waitcnt vmcnt(0)
    s_branch L_sachk
L_saok:
    s_mov_b64 exec, 0xffff
    v_and_b32 v192, 0xffff0000, v192
    v_fmac_f32 v156, 0x45000000, v192
    v_mul_f32 v64, v158, v184
    v_and_b32 v193, 0xffff0000, v193
    v_fmac_f32 v160, 0x45000000, v193
    v_mul_f32 v65, v162, v185
    v_and_b32 v194, 0xffff0000, v194
    v_fmac_f32 v164, 0x45000000, v194
    v_mul_f32 v66, v166, v186
    v_and_b32 v195, 0xffff0000, v195
    v_fmac_f32 v168, 0x45000000, v195
    v_mul_f32 v67, v170, v187
    v_and_b32 v196, 0xffff0000, v196
    v_fmac_f32 v172, 0x45000000, v196
    v_mul_f32 v68, v174, v188
    v_and_b32 v197, 0xffff0000, v197
    v_fmac_f32 v176, 0x45000000, v197
    v_mul_f32 v69, v178, v189
    v_and_b32 v198, 0xffff0000, v198
    v_fmac_f32 v180, 0x45000000, v198
    v_mul_f32 v70, v182, v190
    v_add_f32 v72, v65, v70
    v_sub_f32 v75, v65, v70
    v_add_f32 v73, v66, v69
    v_sub_f32 v76, v66, v69
    v_add_f32 v74, v67, v68
    v_sub_f32 v77, v67, v68
    v_add_f32 v78, v64, v72
    v_add_f32 v78, v78, v73
    v_add_f32 v78, v78, v74
    v_cvt_pk_bf16_f32 v78, v78, 0
    ds_write_b32 v49, v78 offset:5168
    v_fma_f32 v79, s62, v72, v64
    v_mul_f32 v80, s65, v75
    v_fma_f32 v79, s63, v73, v79
    v_fma_f32 v80, s66, v76, v80
    v_fma_f32 v79, s64, v74, v79
    v_fma_f32 v80, s67, v77, v80
    v_mul_f32 v81, v79, v32
    v_mul_f32 v82, v80, v32
    v_fma_f32 v81, -v80, v33, v81
    v_fma_f32 v82, -v79, v33, -v82
    v_cvt_pk_bf16_f32 v84, v81, v82
    ds_write_b32 v49, v84 offset:6256
    v_fma_f32 v79, s63, v72, v64
    v_mul_f32 v80, s66, v75
    v_fma_f32 v79, s64, v73, v79
    v_fma_f32 v80, -s67, v76, v80
    v_fma_f32 v79, s62, v74, v79
    v_fma_f32 v80, -s65, v77, v80
    v_mul_f32 v81, v79, v34
    v_mul_f32 v82, v80, v34
    v_fma_f32 v81, -v80, v35, v81
    v_fma_f32 v82, -v79, v35, -v82
    v_cvt_pk_bf16_f32 v85, v81, v82
    ds_write_b32 v49, v85 offset:7344
    v_fma_f32 v79, s64, v72, v64
    v_mul_f32 v80, s67, v75
    v_fma_f32 v79, s62, v73, v79
    v_fma_f32 v80, -s65, v76, v80
    v_fma_f32 v79, s63, v74, v79
    v_fma_f32 v80, s66, v77, v80
    v_mul_f32 v81, v79, v36
    v_mul_f32 v82, v80, v36
    v_fma_f32 v81, -v80, v37, v81
    v_fma_f32 v82, -v79, v37, -v82
    v_cvt_pk_bf16_f32 v86, v81, v82
    ds_write_b32 v49, v86 offset:8432
    s_mov_b64 exec, -1
    s_branch L_spec1_ret
L_spec2:
    ds_write_b32 v56, v103
    s_mov_b32 exec_lo, 0xffff0000
    ds_write_b32 v57, v103
    s_mov_b64 exec, -1
    s_branch L_spec2_ret
L_long:
L_pad7:
    s_cbranch_execz L_padret
    ds_read_b128 v[64:67], v13 offset:0
    ds_read_b128 v[68:71], v13 offset:1024
    ds_read_b128 v[72:75], v13 offset:2048
    ds_read_b128 v[76:79], v13 offset:3072
    ds_read_b128 v[80:83], v13 offset:4096
    ds_read_b128 v[84:87], v13 offset:5120
    ds_read_b128 v[88:91], v13 offset:6144
    s_add_u32 m0, s15, 0
    s_nop 0
    buffer_load_dwordx4 v232, s[28:31], s61 offen offset:0 sc1 lds
    buffer_load_dwordx4 v232, s[28:31], s61 offen offset:1024 sc1 lds
    buffer_load_dwordx4 v232, s[28:31], s61 offen offset:2048 sc1 lds
    buffer_load_dwordx4 v232, s[28:31], s61 offen offset:3072 sc1 lds
    s_waitcnt vmcnt(4)
    s_barrier
    s_add_u32 m0, s15, 4096
    s_nop 0
    buffer_load_dwordx4 v233, s[28:31], s61 offen offset:0 sc1 lds
    buffer_load_dwordx4 v233, s[28:31], s61 offen offset:1024 sc1 lds
    buffer_load_dwordx4 v233, s[28:31], s61 offen offset:2048 sc1 lds
    buffer_store_dwordx4 v[128:131], v60, s[28:31], s6 offen sc1
    s_mov_b32 exec_hi, 0xffff
    buffer_store_dwordx4 v[132:135], v60, s[28:31], s101 offen sc1
    s_mov_b64 exec, -1
    s_mov_b32 s13, 114688
    s_mov_b32 s4, 0
    s_mov_b32 s5, 0
    s_mov_b32 s8, s61
    s_mov_b32 s9, 28672
    s_mov_b32 s10, s62
    s_mov_b32 s11, 0x10000000
    s_mov_b32 s12, s60
L_longloop:
    s_waitcnt lgkmcnt(3)
    v_mfma_f32_32x32x16_bf16 v[96:111], a[0:3], v[64:67], 0
    ds_read_b128 v[92:95], v13 offset:7168
    s_add_u32 m0, s15, s9
    s_lshl2_add_u32 s59, s11, s18
    v_add_u32 v14, s5, v4
    v_mfma_f32_32x32x16_bf16 v[96:111], a[4:7], v[68:71], v[96:111]
    ds_read_b128 v[64:67], v13 offset:8192
    buffer_load_dwordx4 v232, s[28:31], s10 offen offset:0 sc1 lds
    v_mfma_f32_32x32x16_bf16 v[96:111], a[8:11], v[72:75], v[96:111]
    ds_read_b128 v[68:71], v13 offset:9216
    v_fmaak_f32 v224, v112, v112, 0x409d30fc
    v_fmaak_f32 v225, v113, v113, 0x409d30fc
    v_fmaak_f32 v226, v114, v114, 0x409d30fc
    v_fmaak_f32 v227, v115, v115, 0x409d30fc
    v_mul_f32 v224, v224, v112
    v_mfma_f32_32x32x16_bf16 v[96:111], a[12:15], v[76:79], v[96:111]
    ds_read_b128 v[72:75], v13 offset:10240
    buffer_load_dwordx4 v232, s[28:31], s10 offen offset:1024 sc1 lds
    v_mul_f32 v225, v225, v113
    v_mul_f32 v226, v226, v114
    s_waitcnt lgkmcnt(3)
    v_mfma_f32_32x32x16_bf16 v[96:111], a[16:19], v[80:83], v[96:111]
    ds_read_b128 v[76:79], v13 offset:11264
    v_mul_f32 v227, v227, v115
    v_exp_f32 v224, -v224
    v_mfma_f32_32x32x16_bf16 v[96:111], a[20:23], v[84:87], v[96:111]
    ds_read_b128 v[80:83], v13 offset:12288
    buffer_load_dwordx4 v232, s[28:31], s10 offen offset:2048 sc1 lds
    v_mul_f32 v112, v112, v120
    v_exp_f32 v225, -v225
    v_mfma_f32_32x32x16_bf16 v[96:111], a[24:27], v[88:91], v[96:111]
    ds_read_b128 v[84:87], v13 offset:13312
    v_mul_f32 v113, v113, v121
    v_exp_f32 v226, -v226
    v_mul_f32 v114, v114, v122
    v_mfma_f32_32x32x16_bf16 v[96:111], a[28:31], v[92:95], v[96:111]
    ds_read_b128 v[88:91], v13 offset:14336
    buffer_load_dwordx4 v232, s[28:31], s10 offen offset:3072 sc1 lds
    v_exp_f32 v227, -v227
    s_waitcnt lgkmcnt(3)
    v_mfma_f32_32x32x16_bf16 v[96:111], a[32:35], v[64:67], v[96:111]
    ds_read_b128 v[92:95], v13 offset:15360
    s_add_u32 m0, m0, 4096
    v_mul_f32 v115, v115, v123
    v_fma_f32 v224, v224, v250, v250
    v_mfma_f32_32x32x16_bf16 v[96:111], a[36:39], v[68:71], v[96:111]
    ds_read_b128 v[64:67], v13 offset:16384
    buffer_load_dwordx4 v233, s[28:31], s10 offen offset:0 sc1 lds
    v_fma_f32 v225, v225, v250, v250
    v_fma_f32 v226, v226, v250, v250
    v_mfma_f32_32x32x16_bf16 v[96:111], a[40:43], v[72:75], v[96:111]
    ds_read_b128 v[68:71], v13 offset:17408
    v_fma_f32 v227, v227, v250, v250
    v_rcp_f32 v224, v224
    v_rcp_f32 v225, v225
    v_mfma_f32_32x32x16_bf16 v[96:111], a[44:47], v[76:79], v[96:111]
    ds_read_b128 v[72:75], v13 offset:18432
    buffer_load_dwordx4 v233, s[28:31], s10 offen offset:1024 sc1 lds
    v_rcp_f32 v226, v226
    s_waitcnt lgkmcnt(3)
    v_mfma_f32_32x32x16_bf16 v[96:111], a[48:51], v[80:83], v[96:111]
    ds_read_b128 v[76:79], v13 offset:19456
    v_rcp_f32 v227, v227
    v_mul_f32 v224, v224, v112
    v_mfma_f32_32x32x16_bf16 v[96:111], a[52:55], v[84:87], v[96:111]
    ds_read_b128 v[80:83], v13 offset:20480
    buffer_load_dwordx4 v233, s[28:31], s10 offen offset:2048 sc1 lds
    v_mul_f32 v225, v225, v113
    v_mul_f32 v226, v226, v114
    v_mfma_f32_32x32x16_bf16 v[96:111], a[56:59], v[88:91], v[96:111]
    ds_read_b128 v[84:87], v13 offset:21504
    v_mul_f32 v227, v227, v115
    v_cvt_pk_bf16_f32 v8, v224, v225
    v_cvt_pk_bf16_f32 v9, v226, v227
    v_and_or_b32 v8, v8, v236, s44
    v_and_b32 v9, v236, v9
    v_mfma_f32_32x32x16_bf16 v[96:111], a[60:63], v[92:95], v[96:111]
    ds_read_b128 v[88:91], v13 offset:22528
    s_mov_b32 s11, s12
    s_mov_b32 s12, s8
    s_add_u32 s4, s4, 1
    v_fmaak_f32 v228, v116, v116, 0x409d30fc
    s_waitcnt lgkmcnt(3)
    v_mfma_f32_32x32x16_bf16 v[96:111], a[64:67], v[64:67], v[96:111]
    ds_read_b128 v[92:95], v13 offset:23552
    v_fmaak_f32 v229, v117, v117, 0x409d30fc
    v_fmaak_f32 v230, v118, v118, 0x409d30fc
    v_fmaak_f32 v231, v119, v119, 0x409d30fc
    v_mul_f32 v228, v228, v116
    v_mfma_f32_32x32x16_bf16 v[96:111], a[68:71], v[68:71], v[96:111]
    ds_read_b128 v[64:67], v13 offset:24576
    s_mov_b32 s14, s13
    s_mov_b32 s13, s5
    v_mul_f32 v229, v229, v117
    v_mul_f32 v230, v230, v118
    v_mfma_f32_32x32x16_bf16 v[96:111], a[72:75], v[72:75], v[96:111]
    ds_read_b128 v[68:71], v13 offset:25600
    v_mul_f32 v231, v231, v119
    v_exp_f32 v228, -v228
    v_mul_f32 v116, v116, v124
    v_mfma_f32_32x32x16_bf16 v[96:111], a[76:79], v[76:79], v[96:111]
    ds_read_b128 v[72:75], v13 offset:26624
    s_add_u32 s5, s5, 28672
    s_cmp_eq_u32 s5, 143360
    s_cselect_b32 s5, 0, s5
    v_exp_f32 v229, -v229
    v_mul_f32 v117, v117, v125
    v_exp_f32 v230, -v230
    s_waitcnt lgkmcnt(3)
    v_mfma_f32_32x32x16_bf16 v[96:111], a[80:83], v[80:83], v[96:111]
    ds_read_b128 v[76:79], v13 offset:27648
    s_waitcnt vmcnt(7)
    s_barrier
    v_mfma_f32_32x32x16_bf16 v[96:111], a[84:87], v[84:87], v[96:111]
    ds_read_b128 v[80:83], v14 offset:0
    v_mul_f32 v118, v118, v126
    v_exp_f32 v231, -v231
    v_mul_f32 v119, v119, v127
    v_mfma_f32_32x32x16_bf16 v[96:111], a[88:91], v[88:91], v[96:111]
    ds_read_b128 v[84:87], v14 offset:1024
    v_fma_f32 v228, v228, v250, v250
    v_fma_f32 v229, v229, v250, v250
    v_fma_f32 v230, v230, v250, v250
    v_fma_f32 v231, v231, v250, v250
    v_rcp_f32 v228, v228
    v_mfma_f32_32x32x16_bf16 v[96:111], a[92:95], v[92:95], v[96:111]
    ds_read_b128 v[88:91], v14 offset:2048
    s_add_u32 s9, s9, 28672
    s_cmp_eq_u32 s9, 143360
    s_cselect_b32 s9, 0, s9
    v_rcp_f32 v229, v229
    s_waitcnt lgkmcnt(3)
    v_mfma_f32_32x32x16_bf16 v[96:111], a[96:99], v[64:67], v[96:111]
    ds_read_b128 v[92:95], v14 offset:3072
    v_rcp_f32 v230, v230
    v_rcp_f32 v231, v231
    v_mfma_f32_32x32x16_bf16 v[96:111], a[100:103], v[68:71], v[96:111]
    ds_read_b128 v[64:67], v14 offset:4096
    s_add_u32 s8, s8, 28672
    s_add_u32 s10, s10, 28672
    s_cmp_ge_u32 s4, 6
    s_cselect_b32 s10, 0x40000000, s10
    v_mul_f32 v228, v228, v116
    v_mul_f32 v229, v229, v117
    v_mfma_f32_32x32x16_bf16 v[96:111], a[104:107], v[72:75], v[96:111]
    ds_read_b128 v[68:71], v14 offset:5120
    v_mul_f32 v230, v230, v118
    v_mul_f32 v231, v231, v119
    v_cvt_pk_bf16_f32 v10, v228, v229
    v_cvt_pk_bf16_f32 v11, v230, v231
    v_mfma_f32_32x32x16_bf16 v[96:111], a[108:111], v[76:79], v[96:111]
    ds_read_b128 v[72:75], v14 offset:6144
    v_and_or_b32 v10, v10, v236, 0
    v_and_b32 v11, v236, v11
    buffer_store_dwordx4 v[8:11], v4, s[28:31], s59 offen sc1
    s_waitcnt lgkmcnt(3)
    v_mfma_f32_32x32x16_bf16 v[112:127], a[0:3], v[80:83], 0
    ds_read_b128 v[76:79], v14 offset:7168
    s_add_u32 m0, s15, s9
    s_lshl2_add_u32 s59, s11, s18
    v_add_u32 v13, s5, v4
    v_mfma_f32_32x32x16_bf16 v[112:127], a[4:7], v[84:87], v[112:127]
    ds_read_b128 v[80:83], v14 offset:8192
    buffer_load_dwordx4 v232, s[28:31], s10 offen offset:0 sc1 lds
    v_mfma_f32_32x32x16_bf16 v[112:127], a[8:11], v[88:91], v[112:127]
    ds_read_b128 v[84:87], v14 offset:9216
    v_fmaak_f32 v224, v96, v96, 0x409d30fc
    v_fmaak_f32 v225, v97, v97, 0x409d30fc
    v_fmaak_f32 v226, v98, v98, 0x409d30fc
    v_fmaak_f32 v227, v99, v99, 0x409d30fc
    v_mul_f32 v224, v224, v96
    v_mfma_f32_32x32x16_bf16 v[112:127], a[12:15], v[92:95], v[112:127]
    ds_read_b128 v[88:91], v14 offset:10240
    buffer_load_dwordx4 v232, s[28:31], s10 offen offset:1024 sc1 lds
    v_mul_f32 v225, v225, v97
    v_mul_f32 v226, v226, v98
    s_waitcnt lgkmcnt(3)
    v_mfma_f32_32x32x16_bf16 v[112:127], a[16:19], v[64:67], v[112:127]
    ds_read_b128 v[92:95], v14 offset:11264
    v_mul_f32 v227, v227, v99
    v_exp_f32 v224, -v224
    v_mfma_f32_32x32x16_bf16 v[112:127], a[20:23], v[68:71], v[112:127]
    ds_read_b128 v[64:67], v14 offset:12288
    buffer_load_dwordx4 v232, s[28:31], s10 offen offset:2048 sc1 lds
    v_mul_f32 v96, v96, v104
    v_exp_f32 v225, -v225
    v_mfma_f32_32x32x16_bf16 v[112:127], a[24:27], v[72:75], v[112:127]
    ds_read_b128 v[68:71], v14 offset:13312
    v_mul_f32 v97, v97, v105
    v_exp_f32 v226, -v226
    v_mul_f32 v98, v98, v106
    v_mfma_f32_32x32x16_bf16 v[112:127], a[28:31], v[76:79], v[112:127]
    ds_read_b128 v[72:75], v14 offset:14336
    buffer_load_dwordx4 v232, s[28:31], s10 offen offset:3072 sc1 lds
    v_exp_f32 v227, -v227
    s_waitcnt lgkmcnt(3)
    v_mfma_f32_32x32x16_bf16 v[112:127], a[32:35], v[80:83], v[112:127]
    ds_read_b128 v[76:79], v14 offset:15360
    s_add_u32 m0, m0, 4096
    v_mul_f32 v99, v99, v107
    v_fma_f32 v224, v224, v250, v250
    v_fma_f32 v225, v225, v250, v250
    v_mfma_f32_32x32x16_bf16 v[112:127], a[36:39], v[84:87], v[112:127]
    ds_read_b128 v[80:83], v14 offset:16384
    buffer_load_dwordx4 v233, s[28:31], s10 offen offset:0 sc1 lds
    v_fma_f32 v226, v226, v250, v250
    v_fma_f32 v227, v227, v250, v250
    v_mfma_f32_32x32x16_bf16 v[112:127], a[40:43], v[88:91], v[112:127]
    ds_read_b128 v[84:87], v14 offset:17408
    v_rcp_f32 v224, v224
    v_rcp_f32 v225, v225
    v_mfma_f32_32x32x16_bf16 v[112:127], a[44:47], v[92:95], v[112:127]
    ds_read_b128 v[88:91], v14 offset:18432
    buffer_load_dwordx4 v233, s[28:31], s10 offen offset:1024 sc1 lds
    v_rcp_f32 v226, v226
    s_waitcnt lgkmcnt(3)
    v_mfma_f32_32x32x16_bf16 v[112:127], a[48:51], v[64:67], v[112:127]
    ds_read_b128 v[92:95], v14 offset:19456
    v_rcp_f32 v227, v227
    v_mul_f32 v224, v224, v96
    v_mul_f32 v225, v225, v97
    v_mfma_f32_32x32x16_bf16 v[112:127], a[52:55], v[68:71], v[112:127]
    ds_read_b128 v[64:67], v14 offset:20480
    buffer_load_dwordx4 v233, s[28:31], s10 offen offset:2048 sc1 lds
    v_mul_f32 v226, v226, v98
    v_mul_f32 v227, v227, v99
    v_mfma_f32_32x32x16_bf16 v[112:127], a[56:59], v[72:75], v[112:127]
    ds_read_b128 v[68:71], v14 offset:21504
    v_cvt_pk_bf16_f32 v8, v224, v225
    v_cvt_pk_bf16_f32 v9, v226, v227
    v_and_or_b32 v8, v8, v236, s44
    v_and_b32 v9, v236, v9
    v_mfma_f32_32x32x16_bf16 v[112:127], a[60:63], v[76:79], v[112:127]
    ds_read_b128 v[72:75], v14 offset:22528
    s_mov_b32 s11, s12
    s_mov_b32 s12, s8
    s_add_u32 s4, s4, 1
    v_fmaak_f32 v228, v100, v100, 0x409d30fc
    v_fmaak_f32 v229, v101, v101, 0x409d30fc
    s_waitcnt lgkmcnt(3)
    v_mfma_f32_32x32x16_bf16 v[112:127], a[64:67], v[80:83], v[112:127]
    ds_read_b128 v[76:79], v14 offset:23552
    v_fmaak_f32 v230, v102, v102, 0x409d30fc
    v_fmaak_f32 v231, v103, v103, 0x409d30fc
    v_mul_f32 v228, v228, v100
    v_mfma_f32_32x32x16_bf16 v[112:127], a[68:71], v[84:87], v[112:127]
    ds_read_b128 v[80:83], v14 offset:24576
    s_mov_b32 s14, s13
    s_mov_b32 s13, s5
    v_mul_f32 v229, v229, v101
    v_mul_f32 v230, v230, v102
    v_mul_f32 v231, v231, v103
    v_mfma_f32_32x32x16_bf16 v[112:127], a[72:75], v[88:91], v[112:127]
    ds_read_b128 v[84:87], v14 offset:25600
    v_exp_f32 v228, -v228
    v_mul_f32 v100, v100, v108
    v_exp_f32 v229, -v229
    v_mfma_f32_32x32x16_bf16 v[112:127], a[76:79], v[92:95], v[112:127]
    ds_read_b128 v[88:91], v14 offset:26624
    s_add_u32 s5, s5, 28672
    s_cmp_eq_u32 s5, 143360
    s_cselect_b32 s5, 0, s5
    v_mul_f32 v101, v101, v109
    v_exp_f32 v230, -v230
    s_waitcnt lgkmcnt(3)
    v_mfma_f32_32x32x16_bf16 v[112:127], a[80:83], v[64:67], v[112:127]
    ds_read_b128 v[92:95], v14 offset:27648
    s_waitcnt vmcnt(7)
    s_barrier
    v_mul_f32 v102, v102, v110
    v_mfma_f32_32x32x16_bf16 v[112:127], a[84:87], v[68:71], v[112:127]
    ds_read_b128 v[64:67], v13 offset:0
    v_exp_f32 v231, -v231
    v_mul_f32 v103, v103, v111
    v_fma_f32 v228, v228, v250, v250
    v_mfma_f32_32x32x16_bf16 v[112:127], a[88:91], v[72:75], v[112:127]
    ds_read_b128 v[68:71], v13 offset:1024
    s_cmp_lg_u32 s20, 0
    s_cbranch_scc1 L_nof3
    s_mov_b32 exec_hi, 0
    buffer_store_dword v238, v237, s[28:31], s45 offen sc1
    s_mov_b64 exec, -1
L_nof3:
    s_mov_b32 s45, 0x40000000
    v_fma_f32 v229, v229, v250, v250
    v_fma_f32 v230, v230, v250, v250
    v_fma_f32 v231, v231, v250, v250
    v_rcp_f32 v228, v228
    v_mfma_f32_32x32x16_bf16 v[112:127], a[92:95], v[76:79], v[112:127]
    ds_read_b128 v[72:75], v13 offset:2048
    s_add_u32 s9, s9, 28672
    s_cmp_eq_u32 s9, 143360
    s_cselect_b32 s9, 0, s9
    v_rcp_f32 v229, v229
    s_waitcnt lgkmcnt(3)
    v_mfma_f32_32x32x16_bf16 v[112:127], a[96:99], v[80:83], v[112:127]
    ds_read_b128 v[76:79], v13 offset:3072
    v_rcp_f32 v230, v230
    v_rcp_f32 v231, v231
    v_mfma_f32_32x32x16_bf16 v[112:127], a[100:103], v[84:87], v[112:127]
    ds_read_b128 v[80:83], v13 offset:4096
    s_add_u32 s8, s8, 28672
    s_add_u32 s10, s10, 28672
    s_cmp_ge_u32 s4, 6
    s_cselect_b32 s10, 0x40000000, s10
    v_mul_f32 v228, v228, v100
    v_mul_f32 v229, v229, v101
    v_mfma_f32_32x32x16_bf16 v[112:127], a[104:107], v[88:91], v[112:127]
    ds_read_b128 v[84:87], v13 offset:5120
    v_mul_f32 v230, v230, v102
    v_mul_f32 v231, v231, v103
    v_cvt_pk_bf16_f32 v10, v228, v229
    v_cvt_pk_bf16_f32 v11, v230, v231
    v_mfma_f32_32x32x16_bf16 v[112:127], a[108:111], v[92:95], v[112:127]
    ds_read_b128 v[88:91], v13 offset:6144
    v_and_or_b32 v10, v10, v236, 0
    v_and_b32 v11, v236, v11
    buffer_store_dwordx4 v[8:11], v4, s[28:31], s59 offen sc1
    s_cmp_lt_u32 s4, 8
    s_cbranch_scc1 L_longloop
    s_nop 5
    s_lshl2_add_u32 s59, s11, s18
    v_fmaak_f32 v224, v112, v112, 0x409d30fc
    v_fmaak_f32 v225, v113, v113, 0x409d30fc
    v_fmaak_f32 v226, v114, v114, 0x409d30fc
    v_fmaak_f32 v227, v115, v115, 0x409d30fc
    v_mul_f32 v224, v224, v112
    v_mul_f32 v225, v225, v113
    v_mul_f32 v226, v226, v114
    v_mul_f32 v227, v227, v115
    v_exp_f32 v224, -v224
    v_mul_f32 v112, v112, v120
    v_exp_f32 v225, -v225
    v_mul_f32 v113, v113, v121
    v_exp_f32 v226, -v226
    v_mul_f32 v114, v114, v122
    v_exp_f32 v227, -v227
    v_mul_f32 v115, v115, v123
    v_fma_f32 v224, v224, v250, v250
    v_fma_f32 v225, v225, v250, v250
    v_fma_f32 v226, v226, v250, v250
    v_fma_f32 v227, v227, v250, v250
    v_rcp_f32 v224, v224
    v_rcp_f32 v225, v225
    v_rcp_f32 v226, v226
    v_rcp_f32 v227, v227
    v_mul_f32 v224, v224, v112
    v_mul_f32 v225, v225, v113
    v_mul_f32 v226, v226, v114
    v_mul_f32 v227, v227, v115
    v_cvt_pk_bf16_f32 v8, v224, v225
    v_cvt_pk_bf16_f32 v9, v226, v227
    v_and_or_b32 v8, v8, v236, s44
    v_and_b32 v9, v236, v9
    v_fmaak_f32 v228, v116, v116, 0x409d30fc
    v_fmaak_f32 v229, v117, v117, 0x409d30fc
    v_fmaak_f32 v230, v118, v118, 0x409d30fc
    v_fmaak_f32 v231, v119, v119, 0x409d30fc
    v_mul_f32 v228, v228, v116
    v_mul_f32 v229, v229, v117
    v_mul_f32 v230, v230, v118
    v_mul_f32 v231, v231, v119
    v_exp_f32 v228, -v228
    v_mul_f32 v116, v116, v124
    v_exp_f32 v229, -v229
    v_mul_f32 v117, v117, v125
    v_exp_f32 v230, -v230
    v_mul_f32 v118, v118, v126
    v_exp_f32 v231, -v231
    v_mul_f32 v119, v119, v127
    v_fma_f32 v228, v228, v250, v250
    v_fma_f32 v229, v229, v250, v250
    v_fma_f32 v230, v230, v250, v250
    v_fma_f32 v231, v231, v250, v250
    v_rcp_f32 v228, v228
    v_rcp_f32 v229, v229
    v_rcp_f32 v230, v230
    v_rcp_f32 v231, v231
    v_mul_f32 v228, v228, v116
    v_mul_f32 v229, v229, v117
    v_mul_f32 v230, v230, v118
    v_mul_f32 v231, v231, v119
    v_cvt_pk_bf16_f32 v10, v228, v229
    v_cvt_pk_bf16_f32 v11, v230, v231
    v_and_or_b32 v10, v10, v236, 0
    v_and_b32 v11, v236, v11
    buffer_store_dwordx4 v[8:11], v4, s[28:31], s59 offen sc1
    s_branch L_fin
L_empty:
    buffer_store_dwordx4 v[128:131], v60, s[28:31], s6 offen sc1
    s_mov_b32 exec_hi, 0xffff
    buffer_store_dwordx4 v[132:135], v60, s[28:31], s101 offen sc1
    s_mov_b64 exec, -1
    s_waitcnt vmcnt(0)
    s_barrier
    s_cmp_lg_u32 s20, 0
    s_cbranch_scc1 L_nof4
    s_mov_b32 exec_hi, 0
    buffer_store_dword v238, v237, s[28:31], s45 offen sc1
    s_mov_b64 exec, -1
L_nof4:
    s_cmp_lg_u32 s2, 255
    s_cbranch_scc1 L_epd
    s_cmp_lg_u32 s20, 0
    s_cbranch_scc1 L_epd
    v_lshlrev_b32 v16, 9, v1
    s_mov_b32 s6, 0x210000
    s_mov_b32 s69, 0
L_ep:
    s_sleep 16
    buffer_load_dword v17, v16, s[28:31], s6 offen offset:0 sc1
    buffer_load_dword v18, v16, s[28:31], s6 offen offset:128 sc1
    buffer_load_dword v19, v16, s[28:31], s6 offen offset:256 sc1
    buffer_load_dword v20, v16, s[28:31], s6 offen offset:384 sc1
    s_waitcnt vmcnt(0)
    v_xor_b32 v21, s56, v17
    v_bitop3_b32 v21, v18, s56, v21 bitop3:0xbe
    v_bitop3_b32 v21, v19, s56, v21 bitop3:0xbe
    v_bitop3_b32 v21, v20, s56, v21 bitop3:0xbe
    v_cmp_ne_u32 vcc, 0, v21
    s_add_u32 s69, s69, 1
    s_cmp_gt_u32 s69, 400000
    s_cbranch_scc1 L_ep2
    s_cbranch_vccnz L_ep
L_ep2:
    s_mov_b32 s6, 0x220000
    v_mov_b32 v17, s56
    s_mov_b64 exec, 1
    buffer_store_dword v17, v16, s[28:31], s6 offen sc1
    s_mov_b64 exec, -1
L_epd:
    s_branch L_fin
L_uretry:
L_pad8:
    s_cbranch_execz L_padret
    s_add_u32 s69, s69, 1
    s_cmp_gt_u32 s69, 400000
    s_cbranch_scc1 L_uok
    s_cmp_eq_u64 s[0:1], 0
    s_cbranch_scc1 L_ur0
    buffer_load_dwordx4 v[64:67], v2, s[28:31], s53 offen offset:0 sc1
    buffer_load_dwordx4 v[68:71], v2, s[28:31], s53 offen offset:1024 sc1
L_ur0:
    s_cmp_eq_u64 s[8:9], 0
    s_cbranch_scc1 L_ur1
    buffer_load_dwordx4 v[72:75], v2, s[28:31], s53 offen offset:2048 sc1
    buffer_load_dwordx4 v[76:79], v2, s[28:31], s53 offen offset:3072 sc1
L_ur1:
    s_cmp_eq_u64 s[10:11], 0
    s_cbranch_scc1 L_ur2
    buffer_load_dwordx4 v[80:83], v2, s[28:31], s4 offen offset:0 sc1
    buffer_load_dwordx4 v[84:87], v2, s[28:31], s4 offen offset:1024 sc1
L_ur2:
    s_cmp_eq_u64 s[12:13], 0
    s_cbranch_scc1 L_ur3
    buffer_load_dwordx4 v[88:91], v2, s[28:31], s4 offen offset:2048 sc1
    buffer_load_dwordx4 v[92:95], v2, s[28:31], s4 offen offset:3072 sc1
L_ur3:
    s_cmp_eq_u64 s[44:45], 0
    s_cbranch_scc1 L_ur4
    buffer_load_dwordx4 v[96:99], v2, s[28:31], s5 offen offset:0 sc1
    buffer_load_dwordx4 v[100:103], v2, s[28:31], s5 offen offset:1024 sc1
L_ur4:
    s_cmp_eq_u64 s[54:55], 0
    s_cbranch_scc1 L_ur5
    buffer_load_dwordx4 v[104:107], v2, s[28:31], s5 offen offset:2048 sc1
    buffer_load_dwordx4 v[108:111], v2, s[28:31], s5 offen offset:3072 sc1
L_ur5:
    s_cmp_eq_u64 s[100:101], 0
    s_cbranch_scc1 L_ur6
    buffer_load_dwordx4 v[112:115], v2, s[28:31], s6 offen offset:0 sc1
    buffer_load_dwordx4 v[116:119], v2, s[28:31], s6 offen offset:1024 sc1
L_ur6:
    s_cmp_eq_u64 vcc, 0
    s_cbranch_scc1 L_ur7
    buffer_load_dwordx4 v[120:123], v2, s[28:31], s6 offen offset:2048 sc1
    buffer_load_dwordx4 v[124:127], v2, s[28:31], s6 offen offset:3072 sc1
L_ur7:
    s_cmp_eq_u32 s14, 0
    s_cbranch_scc1 L_urm
    s_mov_b64 exec, 0xfffffff
    buffer_load_dwordx4 v[200:203], v47, s[28:31], s7 offen offset:0 sc1
    buffer_load_dwordx4 v[204:207], v47, s[28:31], s7 offen offset:1792 sc1
    buffer_load_dwordx4 v[208:211], v47, s[28:31], s7 offen offset:3584 sc1
    s_mov_b64 exec, -1
    buffer_load_dword v184, v3, s[28:31], s7 offen offset:1792 sc1
    buffer_load_dword v185, v3, s[28:31], s7 offen offset:2048 sc1
    buffer_load_dword v186, v3, s[28:31], s7 offen offset:2304 sc1
    buffer_load_dword v187, v3, s[28:31], s7 offen offset:2560 sc1
    buffer_load_dword v188, v3, s[28:31], s7 offen offset:2816 sc1
    buffer_load_dword v189, v3, s[28:31], s7 offen offset:3072 sc1
    buffer_load_dword v190, v3, s[28:31], s7 offen offset:3328 sc1
    s_waitcnt vmcnt(0)
    v_xor_b32 v253, s58, v184
    v_bitop3_b32 v253, v185, s58, v253 bitop3:0xbe
    v_bitop3_b32 v253, v186, s58, v253 bitop3:0xbe
    v_bitop3_b32 v253, v187, s58, v253 bitop3:0xbe
    v_bitop3_b32 v253, v188, s58, v253 bitop3:0xbe
    v_bitop3_b32 v253, v189, s58, v253 bitop3:0xbe
    v_bitop3_b32 v253, v190, s58, v253 bitop3:0xbe
    v_bitop3_b32 v253, v200, s58, v253 bitop3:0xbe
    v_bitop3_b32 v253, v204, s58, v253 bitop3:0xbe
    v_bitop3_b32 v253, v208, s58, v253 bitop3:0xbe
    v_lshlrev_b32 v253, 16, v253
    v_cmp_ne_u32 s[16:17], 0, v253
    v_and_b32 v244, 0xffff0000, v200
    v_and_b32 v245, 0xffff0000, v201
    v_and_b32 v246, 0xffff0000, v202
    v_and_b32 v247, 0xffff0000, v203
    ds_write_b128 v44, v[244:247] offset:0
    v_and_b32 v184, 0xffff0000, v184
    v_and_b32 v185, 0xffff0000, v185
    v_and_b32 v186, 0xffff0000, v186
    v_and_b32 v244, 0xffff0000, v204
    v_and_b32 v245, 0xffff0000, v205
    v_and_b32 v246, 0xffff0000, v206
    v_and_b32 v247, 0xffff0000, v207
    v_mul_f32 v244, 0x3eeff558, v244
    v_mul_f32 v245, 0x3eeff558, v245
    v_mul_f32 v246, 0x3eeff558, v246
    v_mul_f32 v247, 0x3eeff558, v247
    ds_write_b128 v44, v[244:247] offset:512
    v_and_b32 v187, 0xffff0000, v187
    v_and_b32 v188, 0xffff0000, v188
    v_and_b32 v189, 0xffff0000, v189
    v_and_b32 v244, 0xffff0000, v208
    v_and_b32 v245, 0xffff0000, v209
    v_and_b32 v246, 0xffff0000, v210
    v_and_b32 v247, 0xffff0000, v211
    ds_write_b128 v44, v[244:247] offset:1024
    v_and_b32 v190, 0xffff0000, v190
    s_or_b32 s14, s16, s17
L_urm:
    s_waitcnt vmcnt(0)
    s_cmp_eq_u64 s[0:1], 0
    s_cbranch_scc1 L_urp0
    v_xor_b32 v252, s57, v67
    v_bitop3_b32 v252, v71, s57, v252 bitop3:0xbe
    v_cmp_lt_u32 s[0:1], s59, v252
    v_perm_b32 v128, v68, v64, s60
    v_perm_b32 v132, v68, v64, s61
    v_perm_b32 v136, v69, v65, s60
    v_perm_b32 v140, v69, v65, s61
    v_perm_b32 v144, v70, v66, s60
    v_perm_b32 v148, v70, v66, s61
    v_perm_b32 v152, v71, v67, s60
L_urp0:
    s_cmp_eq_u64 s[8:9], 0
    s_cbranch_scc1 L_urp1
    v_xor_b32 v252, s57, v75
    v_bitop3_b32 v252, v79, s57, v252 bitop3:0xbe
    v_cmp_lt_u32 s[8:9], s59, v252
    v_perm_b32 v129, v76, v72, s60
    v_perm_b32 v133, v76, v72, s61
    v_perm_b32 v137, v77, v73, s60
    v_perm_b32 v141, v77, v73, s61
    v_perm_b32 v145, v78, v74, s60
    v_perm_b32 v149, v78, v74, s61
    v_perm_b32 v153, v79, v75, s60
L_urp1:
    s_cmp_eq_u64 s[10:11], 0
    s_cbranch_scc1 L_urp2
    v_xor_b32 v252, s57, v83
    v_bitop3_b32 v252, v87, s57, v252 bitop3:0xbe
    v_cmp_lt_u32 s[10:11], s59, v252
    v_perm_b32 v130, v84, v80, s60
    v_perm_b32 v134, v84, v80, s61
    v_perm_b32 v138, v85, v81, s60
    v_perm_b32 v142, v85, v81, s61
    v_perm_b32 v146, v86, v82, s60
    v_perm_b32 v150, v86, v82, s61
    v_perm_b32 v154, v87, v83, s60
L_urp2:
    s_cmp_eq_u64 s[12:13], 0
    s_cbranch_scc1 L_urp3
    v_xor_b32 v252, s57, v91
    v_bitop3_b32 v252, v95, s57, v252 bitop3:0xbe
    v_cmp_lt_u32 s[12:13], s59, v252
    v_perm_b32 v131, v92, v88, s60
    v_perm_b32 v135, v92, v88, s61
    v_perm_b32 v139, v93, v89, s60
    v_perm_b32 v143, v93, v89, s61
    v_perm_b32 v147, v94, v90, s60
    v_perm_b32 v151, v94, v90, s61
    v_perm_b32 v155, v95, v91, s60
L_urp3:
    s_cmp_eq_u64 s[44:45], 0
    s_cbranch_scc1 L_urp4
    v_xor_b32 v252, s57, v99
    v_bitop3_b32 v252, v103, s57, v252 bitop3:0xbe
    v_cmp_lt_u32 s[44:45], s59, v252
    v_perm_b32 v212, v100, v96, s60
    v_perm_b32 v216, v100, v96, s61
    v_perm_b32 v220, v101, v97, s60
    v_perm_b32 v224, v101, v97, s61
    v_perm_b32 v228, v102, v98, s60
    v_perm_b32 v232, v102, v98, s61
    v_perm_b32 v236, v103, v99, s60
L_urp4:
    s_cmp_eq_u64 s[54:55], 0
    s_cbranch_scc1 L_urp5
    v_xor_b32 v252, s57, v107
    v_bitop3_b32 v252, v111, s57, v252 bitop3:0xbe
    v_cmp_lt_u32 s[54:55], s59, v252
    v_perm_b32 v213, v108, v104, s60
    v_perm_b32 v217, v108, v104, s61
    v_perm_b32 v221, v109, v105, s60
    v_perm_b32 v225, v109, v105, s61
    v_perm_b32 v229, v110, v106, s60
    v_perm_b32 v233, v110, v106, s61
    v_perm_b32 v237, v111, v107, s60
L_urp5:
    s_cmp_eq_u64 s[100:101], 0
    s_cbranch_scc1 L_urp6
    v_xor_b32 v252, s57, v115
    v_bitop3_b32 v252, v119, s57, v252 bitop3:0xbe
    v_cmp_lt_u32 s[100:101], s59, v252
    v_perm_b32 v214, v116, v112, s60
    v_perm_b32 v218, v116, v112, s61
    v_perm_b32 v222, v117, v113, s60
    v_perm_b32 v226, v117, v113, s61
    v_perm_b32 v230, v118, v114, s60
    v_perm_b32 v234, v118, v114, s61
    v_perm_b32 v238, v119, v115, s60
L_urp6:
    s_cmp_eq_u64 vcc, 0
    s_cbranch_scc1 L_urp7
    v_xor_b32 v252, s57, v123
    v_bitop3_b32 v252, v127, s57, v252 bitop3:0xbe
    v_cmp_lt_u32 vcc, s59, v252
    v_perm_b32 v215, v124, v120, s60
    v_perm_b32 v219, v124, v120, s61
    v_perm_b32 v223, v125, v121, s60
    v_perm_b32 v227, v125, v121, s61
    v_perm_b32 v231, v126, v122, s60
    v_perm_b32 v235, v126, v122, s61
    v_perm_b32 v239, v127, v123, s60
L_urp7:
    s_nop 1
    s_or_b64 s[16:17], s[0:1], s[8:9]
    s_or_b32 s16, s16, s14
    s_or_b64 s[16:17], s[16:17], s[10:11]
    s_or_b64 s[16:17], s[16:17], s[12:13]
    s_or_b64 s[16:17], s[16:17], s[44:45]
    s_or_b64 s[16:17], s[16:17], s[54:55]
    s_or_b64 s[16:17], s[16:17], s[100:101]
    s_or_b64 s[16:17], s[16:17], vcc
    s_cbranch_scc1 L_uretry
    v_mfma_f32_16x16x32_bf16 v[156:159], v[8:11], v[128:131], 0
    v_mfma_f32_16x16x32_bf16 v[160:163], v[8:11], v[132:135], 0
    v_mfma_f32_16x16x32_bf16 v[164:167], v[8:11], v[136:139], 0
    v_mfma_f32_16x16x32_bf16 v[168:171], v[8:11], v[140:143], 0
    v_mfma_f32_16x16x32_bf16 v[172:175], v[8:11], v[144:147], 0
    v_mfma_f32_16x16x32_bf16 v[176:179], v[8:11], v[148:151], 0
    v_mfma_f32_16x16x32_bf16 v[180:183], v[8:11], v[152:155], 0
    s_branch L_ks1
L_lsetup:
L_pad9:
    s_cbranch_execz L_padret
    s_cmp_eq_u32 s68, 2
    s_cbranch_scc1 L_empty
    v_bfe_u32 v16, v1, 4, 1
    v_bfe_u32 v17, v1, 2, 2
    v_lshrrev_b32 v18, 5, v1
    v_lshl_add_u32 v19, v18, 3, v17
    v_lshlrev_b32 v19, 7, v19
    v_mul_u32_u24 v16, 57344, v16
    v_add_u32 v19, v19, v16
    v_lshrrev_b32 v17, 1, v17
    v_lshl_add_u32 v17, v18, 1, v17
    v_xor_b32 v17, s20, v17
    v_lshl_add_u32 v19, v17, 5, v19
    v_and_b32 v16, 1, v1
    v_bfe_u32 v17, v1, 1, 1
    v_lshl_add_u32 v16, v16, 1, v17
    v_lshl_add_u32 v39, v16, 3, v19
    v_add_u32 v63, 2048, v39
    v_add_u32 v13, 114688, v4
    s_mov_b32 s38, 0
    s_branch L_lsetup_ret
L_gb:
    s_mov_b32 s69, 0
L_gb2:
    buffer_load_dwordx4 v[16:19], v252, s[28:31], s55 offen offset:0 sc1
    buffer_load_dwordx4 v[20:23], v252, s[28:31], s55 offen offset:16 sc1
    s_waitcnt vmcnt(0)
    v_xor_b32 v253, s58, v16
    v_bitop3_b32 v253, v20, s58, v253 bitop3:0xbe
    v_lshlrev_b32 v253, 16, v253
    v_cmp_ne_u32 vcc, 0, v253
    s_add_u32 s69, s69, 1
    s_cmp_gt_u32 s69, 400000
    s_cbranch_scc1 L_gb_ret
    s_cbranch_vccnz L_gb2
    s_branch L_gb_ret
L_f2:
    s_mov_b32 s69, 0
L_f22:
    buffer_load_dword v234, v239, s[28:31], s47 offen sc1
    s_waitcnt vmcnt(0)
    v_cmp_ne_u32 vcc, s56, v234
    s_add_u32 s69, s69, 1
    s_cmp_gt_u32 s69, 400000
    s_cbranch_scc1 L_f2_ret
    s_cbranch_vccnz L_f22
    s_branch L_f2_ret
L_ar_00:
    s_mov_b32 s69, 0
L_ar2_00:
    buffer_load_dwordx4 v[128:131], v24, s[28:31], s8 offen offset:0 sc1
    buffer_load_dwordx4 v[132:135], v24, s[28:31], s8 offen offset:256 sc1
    buffer_load_dwordx4 v[136:139], v25, s[28:31], s8 offen offset:0 sc1
    buffer_load_dwordx4 v[140:143], v25, s[28:31], s8 offen offset:256 sc1
    s_waitcnt vmcnt(0)
    v_xor_b32 v128, s44, v128
    v_or3_b32 v252, v129, v130, v131
    v_xor_b32 v132, s44, v132
    v_or3_b32 v252, v252, v128, v133
    v_or3_b32 v252, v252, v134, v135
    v_xor_b32 v136, s44, v136
    v_or3_b32 v252, v252, v132, v137
    v_or3_b32 v252, v252, v138, v139
    v_xor_b32 v140, s44, v140
    v_or3_b32 v252, v252, v136, v141
    v_or3_b32 v252, v252, v142, v143
    v_bitop3_b32 v252, v252, v140, v236 bitop3:0x54
    v_cmp_ne_u32 vcc, 0, v252
    s_add_u32 s69, s69, 1
    s_cmp_gt_u32 s69, 400000
    s_cbranch_scc1 L_arr_00
    s_cbranch_vccnz L_ar2_00
    s_branch L_arr_00
L_ar_01:
    s_mov_b32 s69, 0
L_ar2_01:
    buffer_load_dwordx4 v[144:147], v26, s[28:31], s14 offen offset:0 sc1
    buffer_load_dwordx4 v[148:151], v26, s[28:31], s14 offen offset:256 sc1
    buffer_load_dwordx4 v[152:155], v27, s[28:31], s14 offen offset:0 sc1
    buffer_load_dwordx4 v[156:159], v27, s[28:31], s14 offen offset:256 sc1
    s_waitcnt vmcnt(0)
    v_xor_b32 v144, s44, v144
    v_or3_b32 v252, v145, v146, v147
    v_xor_b32 v148, s44, v148
    v_or3_b32 v252, v252, v144, v149
    v_or3_b32 v252, v252, v150, v151
    v_xor_b32 v152, s44, v152
    v_or3_b32 v252, v252, v148, v153
    v_or3_b32 v252, v252, v154, v155
    v_xor_b32 v156, s44, v156
    v_or3_b32 v252, v252, v152, v157
    v_or3_b32 v252, v252, v158, v159
    v_bitop3_b32 v252, v252, v156, v236 bitop3:0x54
    v_cmp_ne_u32 vcc, 0, v252
    s_add_u32 s69, s69, 1
    s_cmp_gt_u32 s69, 400000
    s_cbranch_scc1 L_arr_01
    s_cbranch_vccnz L_ar2_01
    s_branch L_arr_01
L_ar_10:
    s_mov_b32 s69, 0
L_ar2_10:
    buffer_load_dwordx4 v[160:163], v24, s[28:31], s9 offen offset:0 sc1
    buffer_load_dwordx4 v[164:167], v24, s[28:31], s9 offen offset:256 sc1
    buffer_load_dwordx4 v[168:171], v25, s[28:31], s9 offen offset:0 sc1
    buffer_load_dwordx4 v[172:175], v25, s[28:31], s9 offen offset:256 sc1
    s_waitcnt vmcnt(0)
    v_xor_b32 v160, s44, v160
    v_or3_b32 v252, v161, v162, v163
    v_xor_b32 v164, s44, v164
    v_or3_b32 v252, v252, v160, v165
    v_or3_b32 v252, v252, v166, v167
    v_xor_b32 v168, s44, v168
    v_or3_b32 v252, v252, v164, v169
    v_or3_b32 v252, v252, v170, v171
    v_xor_b32 v172, s44, v172
    v_or3_b32 v252, v252, v168, v173
    v_or3_b32 v252, v252, v174, v175
    v_bitop3_b32 v252, v252, v172, v236 bitop3:0x54
    v_cmp_ne_u32 vcc, 0, v252
    s_add_u32 s69, s69, 1
    s_cmp_gt_u32 s69, 400000
    s_cbranch_scc1 L_arr_10
    s_cbranch_vccnz L_ar2_10
    s_branch L_arr_10
L_ar_11:
    s_mov_b32 s69, 0
L_ar2_11:
    buffer_load_dwordx4 v[176:179], v26, s[28:31], s8 offen offset:0 sc1
    buffer_load_dwordx4 v[180:183], v26, s[28:31], s8 offen offset:256 sc1
    buffer_load_dwordx4 v[184:187], v27, s[28:31], s8 offen offset:0 sc1
    buffer_load_dwordx4 v[188:191], v27, s[28:31], s8 offen offset:256 sc1
    s_waitcnt vmcnt(0)
    v_xor_b32 v176, s44, v176
    v_or3_b32 v252, v177, v178, v179
    v_xor_b32 v180, s44, v180
    v_or3_b32 v252, v252, v176, v181
    v_or3_b32 v252, v252, v182, v183
    v_xor_b32 v184, s44, v184
    v_or3_b32 v252, v252, v180, v185
    v_or3_b32 v252, v252, v186, v187
    v_xor_b32 v188, s44, v188
    v_or3_b32 v252, v252, v184, v189
    v_or3_b32 v252, v252, v190, v191
    v_bitop3_b32 v252, v252, v188, v236 bitop3:0x54
    v_cmp_ne_u32 vcc, 0, v252
    s_add_u32 s69, s69, 1
    s_cmp_gt_u32 s69, 400000
    s_cbranch_scc1 L_arr_11
    s_cbranch_vccnz L_ar2_11
    s_branch L_arr_11
L_ar_20:
    s_mov_b32 s69, 0
L_ar2_20:
    buffer_load_dwordx4 v[192:195], v24, s[28:31], s10 offen offset:0 sc1
    buffer_load_dwordx4 v[196:199], v24, s[28:31], s10 offen offset:256 sc1
    buffer_load_dwordx4 v[200:203], v25, s[28:31], s10 offen offset:0 sc1
    buffer_load_dwordx4 v[204:207], v25, s[28:31], s10 offen offset:256 sc1
    s_waitcnt vmcnt(0)
    v_xor_b32 v192, s44, v192
    v_or3_b32 v252, v193, v194, v195
    v_xor_b32 v196, s44, v196
    v_or3_b32 v252, v252, v192, v197
    v_or3_b32 v252, v252, v198, v199
    v_xor_b32 v200, s44, v200
    v_or3_b32 v252, v252, v196, v201
    v_or3_b32 v252, v252, v202, v203
    v_xor_b32 v204, s44, v204
    v_or3_b32 v252, v252, v200, v205
    v_or3_b32 v252, v252, v206, v207
    v_bitop3_b32 v252, v252, v204, v236 bitop3:0x54
    v_cmp_ne_u32 vcc, 0, v252
    s_add_u32 s69, s69, 1
    s_cmp_gt_u32 s69, 400000
    s_cbranch_scc1 L_arr_20
    s_cbranch_vccnz L_ar2_20
    s_branch L_arr_20
L_ar_21:
    s_mov_b32 s69, 0
L_ar2_21:
    buffer_load_dwordx4 v[208:211], v26, s[28:31], s9 offen offset:0 sc1
    buffer_load_dwordx4 v[212:215], v26, s[28:31], s9 offen offset:256 sc1
    buffer_load_dwordx4 v[216:219], v27, s[28:31], s9 offen offset:0 sc1
    buffer_load_dwordx4 v[220:223], v27, s[28:31], s9 offen offset:256 sc1
    s_waitcnt vmcnt(0)
    v_xor_b32 v208, s44, v208
    v_or3_b32 v252, v209, v210, v211
    v_xor_b32 v212, s44, v212
    v_or3_b32 v252, v252, v208, v213
    v_or3_b32 v252, v252, v214, v215
    v_xor_b32 v216, s44, v216
    v_or3_b32 v252, v252, v212, v217
    v_or3_b32 v252, v252, v218, v219
    v_xor_b32 v220, s44, v220
    v_or3_b32 v252, v252, v216, v221
    v_or3_b32 v252, v252, v222, v223
    v_bitop3_b32 v252, v252, v220, v236 bitop3:0x54
    v_cmp_ne_u32 vcc, 0, v252
    s_add_u32 s69, s69, 1
    s_cmp_gt_u32 s69, 400000
    s_cbranch_scc1 L_arr_21
    s_cbranch_vccnz L_ar2_21
    s_branch L_arr_21
L_ar_30:
    s_mov_b32 s69, 0
L_ar2_30:
    buffer_load_dwordx4 v[128:131], v24, s[28:31], s11 offen offset:0 sc1
    buffer_load_dwordx4 v[132:135], v24, s[28:31], s11 offen offset:256 sc1
    buffer_load_dwordx4 v[136:139], v25, s[28:31], s11 offen offset:0 sc1
    buffer_load_dwordx4 v[140:143], v25, s[28:31], s11 offen offset:256 sc1
    s_waitcnt vmcnt(0)
    v_xor_b32 v128, s44, v128
    v_or3_b32 v252, v129, v130, v131
    v_xor_b32 v132, s44, v132
    v_or3_b32 v252, v252, v128, v133
    v_or3_b32 v252, v252, v134, v135
    v_xor_b32 v136, s44, v136
    v_or3_b32 v252, v252, v132, v137
    v_or3_b32 v252, v252, v138, v139
    v_xor_b32 v140, s44, v140
    v_or3_b32 v252, v252, v136, v141
    v_or3_b32 v252, v252, v142, v143
    v_bitop3_b32 v252, v252, v140, v236 bitop3:0x54
    v_cmp_ne_u32 vcc, 0, v252
    s_add_u32 s69, s69, 1
    s_cmp_gt_u32 s69, 400000
    s_cbranch_scc1 L_arr_30
    s_cbranch_vccnz L_ar2_30
    s_branch L_arr_30
L_ar_31:
    s_mov_b32 s69, 0
L_ar2_31:
    buffer_load_dwordx4 v[144:147], v26, s[28:31], s10 offen offset:0 sc1
    buffer_load_dwordx4 v[148:151], v26, s[28:31], s10 offen offset:256 sc1
    buffer_load_dwordx4 v[152:155], v27, s[28:31], s10 offen offset:0 sc1
    buffer_load_dwordx4 v[156:159], v27, s[28:31], s10 offen offset:256 sc1
    s_waitcnt vmcnt(0)
    v_xor_b32 v144, s44, v144
    v_or3_b32 v252, v145, v146, v147
    v_xor_b32 v148, s44, v148
    v_or3_b32 v252, v252, v144, v149
    v_or3_b32 v252, v252, v150, v151
    v_xor_b32 v152, s44, v152
    v_or3_b32 v252, v252, v148, v153
    v_or3_b32 v252, v252, v154, v155
    v_xor_b32 v156, s44, v156
    v_or3_b32 v252, v252, v152, v157
    v_or3_b32 v252, v252, v158, v159
    v_bitop3_b32 v252, v252, v156, v236 bitop3:0x54
    v_cmp_ne_u32 vcc, 0, v252
    s_add_u32 s69, s69, 1
    s_cmp_gt_u32 s69, 400000
    s_cbranch_scc1 L_arr_31
    s_cbranch_vccnz L_ar2_31
    s_branch L_arr_31
L_ar_40:
    s_mov_b32 s69, 0
L_ar2_40:
    buffer_load_dwordx4 v[160:163], v24, s[28:31], s12 offen offset:0 sc1
    buffer_load_dwordx4 v[164:167], v24, s[28:31], s12 offen offset:256 sc1
    buffer_load_dwordx4 v[168:171], v25, s[28:31], s12 offen offset:0 sc1
    buffer_load_dwordx4 v[172:175], v25, s[28:31], s12 offen offset:256 sc1
    s_waitcnt vmcnt(0)
    v_xor_b32 v160, s44, v160
    v_or3_b32 v252, v161, v162, v163
    v_xor_b32 v164, s44, v164
    v_or3_b32 v252, v252, v160, v165
    v_or3_b32 v252, v252, v166, v167
    v_xor_b32 v168, s44, v168
    v_or3_b32 v252, v252, v164, v169
    v_or3_b32 v252, v252, v170, v171
    v_xor_b32 v172, s44, v172
    v_or3_b32 v252, v252, v168, v173
    v_or3_b32 v252, v252, v174, v175
    v_bitop3_b32 v252, v252, v172, v236 bitop3:0x54
    v_cmp_ne_u32 vcc, 0, v252
    s_add_u32 s69, s69, 1
    s_cmp_gt_u32 s69, 400000
    s_cbranch_scc1 L_arr_40
    s_cbranch_vccnz L_ar2_40
    s_branch L_arr_40
L_ar_50:
    s_mov_b32 s69, 0
L_ar2_50:
    buffer_load_dwordx4 v[192:195], v24, s[28:31], s13 offen offset:0 sc1
    buffer_load_dwordx4 v[196:199], v24, s[28:31], s13 offen offset:256 sc1
    buffer_load_dwordx4 v[200:203], v25, s[28:31], s13 offen offset:0 sc1
    buffer_load_dwordx4 v[204:207], v25, s[28:31], s13 offen offset:256 sc1
    s_waitcnt vmcnt(0)
    v_xor_b32 v192, s44, v192
    v_or3_b32 v252, v193, v194, v195
    v_xor_b32 v196, s44, v196
    v_or3_b32 v252, v252, v192, v197
    v_or3_b32 v252, v252, v198, v199
    v_xor_b32 v200, s44, v200
    v_or3_b32 v252, v252, v196, v201
    v_or3_b32 v252, v252, v202, v203
    v_xor_b32 v204, s44, v204
    v_or3_b32 v252, v252, v200, v205
    v_or3_b32 v252, v252, v206, v207
    v_bitop3_b32 v252, v252, v204, v236 bitop3:0x54
    v_cmp_ne_u32 vcc, 0, v252
    s_add_u32 s69, s69, 1
    s_cmp_gt_u32 s69, 400000
    s_cbranch_scc1 L_arr_50
    s_cbranch_vccnz L_ar2_50
    s_branch L_arr_50
L_ar_60:
    s_mov_b32 s69, 0
L_ar2_60:
    buffer_load_dwordx4 v[128:131], v24, s[28:31], s14 offen offset:0 sc1
    buffer_load_dwordx4 v[132:135], v24, s[28:31], s14 offen offset:256 sc1
    buffer_load_dwordx4 v[136:139], v25, s[28:31], s14 offen offset:0 sc1
    buffer_load_dwordx4 v[140:143], v25, s[28:31], s14 offen offset:256 sc1
    s_waitcnt vmcnt(0)
    v_xor_b32 v128, s44, v128
    v_or3_b32 v252, v129, v130, v131
    v_xor_b32 v132, s44, v132
    v_or3_b32 v252, v252, v128, v133
    v_or3_b32 v252, v252, v134, v135
    v_xor_b32 v136, s44, v136
    v_or3_b32 v252, v252, v132, v137
    v_or3_b32 v252, v252, v138, v139
    v_xor_b32 v140, s44, v140
    v_or3_b32 v252, v252, v136, v141
    v_or3_b32 v252, v252, v142, v143
    v_bitop3_b32 v252, v252, v140, v236 bitop3:0x54
    v_cmp_ne_u32 vcc, 0, v252
    s_add_u32 s69, s69, 1
    s_cmp_gt_u32 s69, 400000
    s_cbranch_scc1 L_arr_60
    s_cbranch_vccnz L_ar2_60
    s_branch L_arr_60
L_ar_41:
    s_mov_b32 s69, 0
L_ar2_41:
    buffer_load_dwordx4 v[176:179], v26, s[28:31], s11 offen offset:0 sc1
    buffer_load_dwordx4 v[180:183], v26, s[28:31], s11 offen offset:256 sc1
    buffer_load_dwordx4 v[184:187], v27, s[28:31], s11 offen offset:0 sc1
    buffer_load_dwordx4 v[188:191], v27, s[28:31], s11 offen offset:256 sc1
    s_waitcnt vmcnt(0)
    v_xor_b32 v176, s44, v176
    v_or3_b32 v252, v177, v178, v179
    v_xor_b32 v180, s44, v180
    v_or3_b32 v252, v252, v176, v181
    v_or3_b32 v252, v252, v182, v183
    v_xor_b32 v184, s44, v184
    v_or3_b32 v252, v252, v180, v185
    v_or3_b32 v252, v252, v186, v187
    v_xor_b32 v188, s44, v188
    v_or3_b32 v252, v252, v184, v189
    v_or3_b32 v252, v252, v190, v191
    v_bitop3_b32 v252, v252, v188, v236 bitop3:0x54
    v_cmp_ne_u32 vcc, 0, v252
    s_add_u32 s69, s69, 1
    s_cmp_gt_u32 s69, 400000
    s_cbranch_scc1 L_arr_41
    s_cbranch_vccnz L_ar2_41
    s_branch L_arr_41
L_ar_51:
    s_mov_b32 s69, 0
L_ar2_51:
    buffer_load_dwordx4 v[208:211], v26, s[28:31], s12 offen offset:0 sc1
    buffer_load_dwordx4 v[212:215], v26, s[28:31], s12 offen offset:256 sc1
    buffer_load_dwordx4 v[216:219], v27, s[28:31], s12 offen offset:0 sc1
    buffer_load_dwordx4 v[220:223], v27, s[28:31], s12 offen offset:256 sc1
    s_waitcnt vmcnt(0)
    v_xor_b32 v208, s44, v208
    v_or3_b32 v252, v209, v210, v211
    v_xor_b32 v212, s44, v212
    v_or3_b32 v252, v252, v208, v213
    v_or3_b32 v252, v252, v214, v215
    v_xor_b32 v216, s44, v216
    v_or3_b32 v252, v252, v212, v217
    v_or3_b32 v252, v252, v218, v219
    v_xor_b32 v220, s44, v220
    v_or3_b32 v252, v252, v216, v221
    v_or3_b32 v252, v252, v222, v223
    v_bitop3_b32 v252, v252, v220, v236 bitop3:0x54
    v_cmp_ne_u32 vcc, 0, v252
    s_add_u32 s69, s69, 1
    s_cmp_gt_u32 s69, 400000
    s_cbranch_scc1 L_arr_51
    s_cbranch_vccnz L_ar2_51
    s_branch L_arr_51
L_ar_61:
    s_mov_b32 s69, 0
L_ar2_61:
    buffer_load_dwordx4 v[144:147], v26, s[28:31], s13 offen offset:0 sc1
    buffer_load_dwordx4 v[148:151], v26, s[28:31], s13 offen offset:256 sc1
    buffer_load_dwordx4 v[152:155], v27, s[28:31], s13 offen offset:0 sc1
    buffer_load_dwordx4 v[156:159], v27, s[28:31], s13 offen offset:256 sc1
    s_waitcnt vmcnt(0)
    v_xor_b32 v144, s44, v144
    v_or3_b32 v252, v145, v146, v147
    v_xor_b32 v148, s44, v148
    v_or3_b32 v252, v252, v144, v149
    v_or3_b32 v252, v252, v150, v151
    v_xor_b32 v152, s44, v152
    v_or3_b32 v252, v252, v148, v153
    v_or3_b32 v252, v252, v154, v155
    v_xor_b32 v156, s44, v156
    v_or3_b32 v252, v252, v152, v157
    v_or3_b32 v252, v252, v158, v159
    v_bitop3_b32 v252, v252, v156, v236 bitop3:0x54
    v_cmp_ne_u32 vcc, 0, v252
    s_add_u32 s69, s69, 1
    s_cmp_gt_u32 s69, 400000
    s_cbranch_scc1 L_arr_61
    s_cbranch_vccnz L_ar2_61
    s_branch L_arr_61
L_codeend:
    s_endpgm
.section .rodata,"a"
.p2align 6
.amdhsa_kernel adaLN_cond__spectral_fnet__geglu_ffn__prompt_kernel
  .amdhsa_next_free_vgpr 512
  .amdhsa_next_free_sgpr 102
  .amdhsa_accum_offset 256
  .amdhsa_group_segment_fixed_size 0
  .amdhsa_kernarg_size 112
  .amdhsa_user_sgpr_count 2
  .amdhsa_user_sgpr_kernarg_segment_ptr 1
  .amdhsa_system_sgpr_workgroup_id_x 1
.end_amdhsa_kernel
```
